```python
import torch

def _softmax(x, axis=-1):
    return torch.softmax(x, dim=axis)
def _gelu(x):
    return torch.nn.functional.gelu(x, approximate="tanh")
def _silu(x):
    return torch.nn.functional.silu(x)
def _sigmoid(x):
    return torch.sigmoid(x)
def _layernorm(x, axis=-1, eps=1e-5):
    m = x.mean(dim=axis, keepdim=True)
    v = x.var(dim=axis, keepdim=True, unbiased=False)
    return (x - m) / torch.sqrt(v + eps)
def _scatter_add(tgt, idx, src, axis=0):
    return tgt.clone().index_add_(axis, idx, src)
def _segment_sum(src, seg, n):
    out = torch.zeros((n,) + src.shape[1:], dtype=src.dtype)
    return out.index_add_(0, seg, src)
def _pad(x, pw):
    flat = tuple(v for pair in reversed(pw) for v in pair)
    return torch.nn.functional.pad(x, flat)

kernel_name = 'sequential_preLN__linear_attn_block__swiglu_ffn__prompt'

def setup_inputs():

    _w = (lambda a: (lambda t: t.to(torch.bfloat16) if t.is_floating_point() else t)(torch.as_tensor(a)))
    def _A_setup():
        B, S, D = 1, 2048, 448
        return {
            "x": _w((lambda *s: torch.randn(*s, dtype=torch.bfloat16) * 0.05)(B, S, D)),
            "wqkv": _w((lambda *s: torch.randn(*s, dtype=torch.bfloat16) * 0.1)(D, 3 * D)),
            "wo": _w((lambda *s: torch.randn(*s, dtype=torch.bfloat16) * 0.05)(D, D)),
        }
    _A_in = _A_setup()

    def _B_setup():
        B, S, D, F = 1, 2048, 448, 1792
        return {
            "x": _w((lambda *s: torch.randn(*s, dtype=torch.bfloat16) * 0.05)(B, S, D)),
            "w_gate": _w((lambda *s: torch.randn(*s, dtype=torch.bfloat16) * 0.05)(D, F)),
            "w_up": _w((lambda *s: torch.randn(*s, dtype=torch.bfloat16) * 0.05)(D, F)),
            "w_down": _w((lambda *s: torch.randn(*s, dtype=torch.bfloat16) * 0.05)(F, D)),
        }
    _B_in = _B_setup()

    return {
        "A_x": _A_in["x"],
        "A_wqkv": _A_in["wqkv"],
        "A_wo": _A_in["wo"],
        "B_x": _B_in["x"],
        "B_w_gate": _B_in["w_gate"],
        "B_w_up": _B_in["w_up"],
        "B_w_down": _B_in["w_down"],
    }

def reference(A_x, A_wqkv, A_wo, B_x, B_w_gate, B_w_up, B_w_down):
    def _A_ref(x, wqkv, wo):
        B, S, D = x.shape
        H = 16; Dh = D // H
        qkv = (lambda x, *d: x.permute(*d))((x @ wqkv).reshape(B, S, 3, H, Dh), 2, 0, 3, 1, 4)
        q, k, v = qkv[0], qkv[1], qkv[2]
        phi = lambda t: torch.where(t > 0, t + 1, torch.exp(t)) + 1e-6
        pq, pk = phi(q), phi(k)
        kv = torch.einsum("bhsd,bhse->bhde", pk, v)
        z = torch.einsum("bhsd->bhd", pk)
        num = torch.einsum("bhqd,bhde->bhqe", pq, kv)
        den = torch.einsum("bhqd,bhd->bhq", pq, z)[..., None] + 1e-6
        o = num / den
        return (lambda x, *d: x.permute(*d))(o, 0, 2, 1, 3).reshape(B, S, D) @ wo

    def _B_ref(x, w_gate, w_up, w_down):
        g = _silu(x @ w_gate)
        u = x @ w_up
        return (g * u) @ w_down

    x = A_x
    h = x + _A_ref(_layernorm(x, axis=-1), A_wqkv, A_wo)
    h2 = h + _B_ref(_layernorm(h, axis=-1), B_w_gate, B_w_up, B_w_down)
    return h2
```

```asm
; @launch grid=(256,1,1) block=(256,1,1) lds=163840
.amdgcn_target "amdgcn-amd-amdhsa--gfx950"
.text
.globl sequential_preLN__linear_attn_block__swiglu_ffn__prompt_kernel
.p2align 8
.type sequential_preLN__linear_attn_block__swiglu_ffn__prompt_kernel,@function
sequential_preLN__linear_attn_block__swiglu_ffn__prompt_kernel:
    s_cmp_ge_u32 s2, 256
    s_cbranch_scc1 kf_end
    s_load_dwordx16 s[4:19], s[0:1], 0
    s_load_dwordx4 s[20:23], s[0:1], 64
    s_getpc_b64 s[88:89]
    v_lshrrev_b32 v2, 6, v0
    v_and_b32 v1, 63, v0
    s_lshr_b32 s78, s2, 3
    s_mul_i32 s79, s78, 12
    v_mul_u32_u24 v3, 3, v2
    v_add3_u32 v3, v3, v1, s79
    v_lshlrev_b32 v3, 7, v3
    s_mov_b64 exec, 7
    global_load_dword v248, v3, s[88:89]
    s_mov_b64 exec, -1
    v_readfirstlane_b32 s68, v2
    s_and_b32 s77, s2, 7
    s_lshr_b32 s79, s77, 1
    s_lshl_b32 s79, s79, 2
    s_and_b32 s80, s78, 3
    s_add_u32 s69, s79, s80
    s_and_b32 s81, s77, 1
    s_lshr_b32 s82, s78, 2
    s_lshl_b32 s70, s81, 3
    s_add_u32 s70, s70, s82
    s_lshl_b32 s71, s80, 1
    s_add_u32 s71, s71, s82
    s_sub_u32 s83, s71, 7
    s_cmp_ge_u32 s71, 7
    s_cselect_b32 s71, s83, s71
    s_and_b32 s79, s77, 3
    s_lshr_b32 s80, s77, 2
    s_lshr_b32 s81, s78, 2
    s_and_b32 s82, s78, 3
    s_mul_i32 s83, s78, 86
    s_lshr_b32 s83, s83, 8
    s_mul_i32 s84, s83, 3
    s_sub_u32 s84, s78, s84
    s_lshl_b32 s75, s79, 2
    s_mul_i32 s73, s79, 3
    s_add_u32 s73, s73, 2
    s_lshl_b32 s72, s79, 5
    s_mul_i32 s76, s79, 24
    s_add_u32 s76, s76, 16
    s_cmp_lt_u32 s79, 2
    s_cselect_b32 s81, s81, s83
    s_cselect_b32 s82, s82, s84
    s_cselect_b32 s75, s75, s73
    s_cselect_b32 s83, s72, s76
    s_cselect_b32 s84, 32, 24
    s_add_u32 s75, s75, s82
    s_and_b32 s81, s81, 7
    s_and_b32 s76, s81, 3
    s_lshl_b32 s74, s80, 3
    s_add_u32 s74, s74, s81
    s_cmp_ge_u32 s78, s84
    s_cselect_b32 s82, 0, s78
    s_mul_i32 s81, s80, 112
    s_add_u32 s81, s81, s83
    s_add_u32 s81, s81, s82
    s_mul_i32 s72, s81, 9363
    s_lshr_b32 s72, s72, 16
    s_mul_i32 s82, s72, 7
    s_sub_u32 s73, s81, s82
    s_mul_i32 s92, s2, 9363
    s_lshr_b32 s92, s92, 16
    s_mul_i32 s93, s92, 7
    s_sub_u32 s93, s2, s93
    v_lshrrev_b32 v2, 3, v1
    v_lshrrev_b32 v3, 4, v1
    v_and_b32 v4, 7, v1
    v_xor_b32 v5, v4, v3
    v_lshlrev_b32 v5, 4, v5
    v_mul_u32_u24 v6, 896, v2
    v_add_u32 v204, v6, v5
    v_xor_b32 v205, 64, v204
    v_add_u32 v205, 7168, v205
    v_add_u32 v206, 14336, v204
    v_add_u32 v207, 14336, v205
    v_lshrrev_b32 v5, 2, v1
    v_and_b32 v6, 3, v1
    v_mul_u32_u24 v7, 2688, v5
    v_lshl_add_u32 v208, v6, 4, v7
    v_lshlrev_b32 v240, 4, v1
    v_and_b32 v5, 15, v1
    v_lshlrev_b32 v5, 4, v5
    v_lshl_add_u32 v5, v3, 14, v5
    v_mov_b32 v200, 0
    v_mov_b32 v201, 0
    v_mov_b32 v202, 0
    v_mov_b32 v203, 0
    s_lshl_b32 s94, s68, 10
    s_lshl_b32 s95, s68, 12
    s_lshl_b32 s77, s69, 2
    s_add_u32 s77, s77, s68
    s_mul_i32 s96, s77, 28672
    s_mul_i32 s97, s70, 56
    s_mul_i32 s78, s68, 43008
    s_add_u32 s97, s97, s78
    s_mul_i32 s98, s68, 12288
    s_add_u32 s98, s98, 108544
    s_mov_b32 s99, s71
    s_mov_b32 s3, s71
    s_waitcnt lgkmcnt(0)
    s_mov_b32 s24, s4
    s_mov_b32 s25, s5
    s_mov_b32 s26, 0x1c0000
    s_mov_b32 s27, 0x20000
    s_mov_b32 s28, s6
    s_mov_b32 s29, s7
    s_mov_b32 s30, 0x126000
    s_mov_b32 s31, 0x20000
    s_mul_i32 s78, s99, 172032
    s_lshl_b32 s79, s99, 12
    s_add_u32 s79, s79, s94
    s_add_u32 m0, s79, 50304
    s_add_u32 s78, s78, s97
    buffer_load_dwordx4 v208, s[28:31], s78 offen offset:896 lds
    s_add_u32 m0, s79, 78080
    s_lshl_b32 s77, s99, 7
    buffer_load_dwordx4 v208, s[28:31], s78 offen offset:1792 lds
    s_add_u32 m0, s98, 0
    s_add_u32 s77, s77, s96
    buffer_load_dwordx4 v204, s[24:27], s77 offen lds
    s_add_u32 m0, s98, 1024
    s_add_u32 s99, s99, 1
    s_cmp_eq_u32 s99, 7
    s_cselect_b32 s99, 0, s99
    buffer_load_dwordx4 v205, s[24:27], s77 offen lds
    s_add_u32 m0, s98, 2048
    s_nop 0
    buffer_load_dwordx4 v206, s[24:27], s77 offen lds
    s_add_u32 m0, s98, 3072
    s_nop 0
    buffer_load_dwordx4 v207, s[24:27], s77 offen lds
    s_mov_b32 s56, s22
    s_mov_b32 s57, s23
    s_mov_b32 s58, 0x10000000
    s_mov_b32 s59, 0x20000
    s_mov_b32 s60, s22
    s_mov_b32 s61, s23
    s_mov_b32 s62, 0x10000000
    s_mov_b32 s63, 0x20000
    s_mov_b32 s64, s20
    s_mov_b32 s65, s21
    s_mov_b32 s66, 0x100
    s_mov_b32 s67, 0x20000
    s_cmp_eq_u32 s69, 0
    s_cselect_b32 s62, 0x10000000, 0
    s_cselect_b32 s66, 256, 0
    s_mov_b32 s44, s16
    s_mov_b32 s45, s17
    s_mov_b32 s46, 0x188000
    s_mov_b32 s47, 0x20000
    s_mov_b32 s48, s18
    s_mov_b32 s49, s19
    s_mov_b32 s50, 0x1c0000
    s_mov_b32 s51, 0x20000
    s_mov_b32 s52, s20
    s_mov_b32 s53, s21
    s_mov_b32 s54, 0x100
    s_mov_b32 s55, 0x20000
    s_mov_b32 s40, s22
    s_mov_b32 s41, s23
    s_mov_b32 s42, 0x10000000
    s_mov_b32 s43, 0x20000
    s_cmp_lt_u32 s92, 28
    s_cselect_b32 s32, s12, s8
    s_cselect_b32 s36, s14, s8
    s_cselect_b32 s33, s13, s9
    s_cselect_b32 s37, s15, s9
    s_mov_b32 s34, 401408
    s_cmov_b32 s34, 1605632
    s_mov_b32 s35, 0x20000
    s_mov_b32 s39, 0x20000
    s_cmp_lt_u32 s92, 32
    s_cselect_b32 s34, s34, 0
    s_mov_b32 s38, s34
    s_cselect_b32 s42, 0x10000000, 0
    s_lshl_b32 s80, s70, 12
    s_add_u32 s80, s80, s94
    s_add_u32 s80, s80, 2097152
    buffer_store_dwordx4 v[200:203], v240, s[60:63], s80 offen sc0 sc1
    s_lshl_b32 s80, s70, 8
    s_add_u32 s80, s80, s95
    s_add_u32 s80, s80, 2228224
    s_mov_b32 exec_hi, 0
    buffer_store_dwordx4 v[200:203], v5, s[60:63], s80 offen sc0 sc1
    s_lshl_b32 s80, s70, 10
    s_lshl_b32 s81, s68, 8
    s_add_u32 s80, s80, s81
    s_add_u32 s80, s80, 2883584
    s_mov_b32 exec_lo, 0xffff
    buffer_store_dwordx4 v[200:203], v240, s[60:63], s80 offen sc0 sc1
    s_mov_b64 exec, -1
    s_mov_b32 s4, s96
    s_mov_b32 s5, s97
    s_mov_b32 s6, s98
    s_mov_b32 s7, s99
    s_mov_b32 s8, s3
    s_mov_b32 s9, s94
    s_mov_b32 s10, s95
    s_lshl_b32 s81, s93, 2
    s_add_u32 s81, s81, s68
    s_mul_i32 s82, s81, 57344
    s_lshl_b32 s83, s92, 7
    s_add_u32 s11, s82, s83
    s_mul_i32 s82, s92, 112
    s_add_u32 s82, s82, s81
    s_lshl_b32 s82, s82, 10
    s_add_u32 s15, s82, 5242880
    s_lshr_b32 s19, s92, 1
    s_lshl_b32 s19, s19, 8
    s_add_u32 s19, s19, 2240512
    s_sub_u32 s81, s92, 28
    s_lshl_b32 s81, s81, 2
    s_add_u32 s81, s81, s68
    s_mul_i32 s82, s81, 25088
    s_lshl_b32 s83, s93, 7
    s_add_u32 s12, s82, s83
    s_lshl_b32 s82, s93, 16
    s_lshl_b32 s83, s81, 11
    s_add_u32 s82, s82, s83
    s_add_u32 s16, s82, 2359296
    s_lshl_b32 s82, s93, 8
    s_add_u32 s82, s82, 2244608
    s_cmp_lt_u32 s92, 32
    s_cselect_b32 s82, s82, 0x20000000
    s_cmp_lt_u32 s92, 28
    s_cselect_b32 s11, s11, s12
    s_cselect_b32 s15, s15, s16
    s_cselect_b32 s19, s19, s82
    s_mul_i32 s20, s92, 512
    s_cselect_b32 s20, s20, 0x20000000
    s_mov_b32 s80, 896
    s_cmov_b32 s80, 3584
    s_mov_b32 s81, 7168
    s_cmov_b32 s81, 28672
    s_cselect_b32 s82, 0, 14336
    s_mov_b32 s83, 1024
    s_cmov_b32 s83, 28672
    s_mov_b32 s84, 32768
    s_cmov_b32 s84, 57344
    s_mov_b32 s85, 32
    s_cmov_b32 s85, 2048
    s_mov_b32 s86, 1792
    s_cmov_b32 s86, 1024
    s_cselect_b32 s87, 32, 1024
    s_add_u32 s12, s11, s81
    s_add_u32 s13, s11, s82
    s_add_u32 s14, s13, s81
    s_add_u32 s16, s15, s83
    s_add_u32 s17, s15, s84
    s_add_u32 s18, s17, s83
    v_mul_lo_u32 v5, v2, s80
    v_lshl_add_u32 v236, v4, 4, v5
    v_lshrrev_b32 v2, 5, v1
    v_bfe_u32 v3, v1, 4, 1
    v_bfe_u32 v4, v1, 2, 2
    v_and_b32 v5, 3, v1
    s_mul_i32 s95, s68, 4608
    s_add_u32 s95, s95, 32768
    v_mul_lo_u32 v6, v3, s85
    v_mul_lo_u32 v7, v2, s86
    v_add3_u32 v6, v6, v7, s95
    v_lshl_add_u32 v6, v4, 7, v6
    v_lshl_add_u32 v232, v5, 3, v6
    v_add_u32 v233, s87, v232
    v_add_u32 v234, 64, v232
    v_add_u32 v235, 64, v233
    v_lshlrev_b32 v6, 9, v2
    v_lshl_add_u32 v6, v4, 6, v6
    v_lshl_add_u32 v6, v5, 3, v6
    v_lshl_add_u32 v213, v3, 5, v6
    v_add_u32 v213, 51200, v213
    v_and_b32 v6, 31, v1
    v_lshlrev_b32 v224, 2, v6
    v_lshrrev_b32 v7, 3, v6
    v_lshlrev_b32 v7, 10, v7
    v_and_b32 v3, 7, v6
    v_lshl_add_u32 v7, v3, 7, v7
    v_bfe_u32 v3, v6, 1, 3
    v_xor_b32 v3, v3, v2
    v_lshl_add_u32 v7, v3, 4, v7
    v_add_u32 v209, s6, v7
    v_xor_b32 v210, 32, v209
    v_xor_b32 v211, 64, v209
    v_xor_b32 v212, 96, v209
    v_mul_u32_u24 v7, 896, v6
    v_lshl_add_u32 v251, v2, 4, v7
    v_cmp_eq_u32 s[88:89], 28, v6
    v_cmp_eq_u32 s[90:91], 0, v2
    s_mov_b32 s85, 0x3f803f80
    s_mov_b32 s86, 0x358637bd
    s_mov_b32 s87, 0x3fb8aa3b
    v_mov_b32 v200, s85
    v_mov_b32 v201, s85
    v_mov_b32 v202, s85
    v_mov_b32 v203, s85
    v_mov_b32 v216, 0
    v_mov_b32 v217, 0
    v_mov_b32 v218, 0
    v_mov_b32 v219, 0
    s_lshl_b32 s80, s68, 7
    s_add_u32 s80, s80, 29696
    v_add_u32 v225, s80, v224
    s_lshl_b32 s80, s68, 8
    s_add_u32 s80, s80, 28672
    v_lshlrev_b32 v3, 4, v2
    v_add_u32 v226, s80, v3
    s_xor_b32 s80, s68, 1
    s_mul_i32 s80, s80, 12288
    s_add_u32 s80, s80, 0
    v_add_u32 v244, s80, v240
    s_xor_b32 s80, s68, 2
    s_mul_i32 s80, s80, 12288
    s_add_u32 s80, s80, 4096
    v_add_u32 v245, s80, v240
    s_xor_b32 s80, s68, 3
    s_mul_i32 s80, s80, 12288
    s_add_u32 s80, s80, 8192
    v_add_u32 v246, s80, v240
    s_mul_i32 s80, s68, 12288
    s_add_u32 s80, s80, 0
    v_add_u32 v247, s80, v240
    v_add_u32 v241, 4096, v240
    v_add_u32 v242, 28672, v240
    v_add_u32 v243, 32768, v240
    s_lshl_b32 s80, s75, 2
    s_add_u32 s80, s80, s68
    s_mul_i32 s80, s80, 57344
    s_add_u32 s80, s80, 5242880
    s_add_u32 s81, s76, 0
    s_and_b32 s81, s81, 3
    s_mul_i32 s81, s81, 7168
    s_add_u32 s96, s81, s80
    s_add_u32 s81, s76, 1
    s_and_b32 s81, s81, 3
    s_mul_i32 s81, s81, 7168
    s_add_u32 s97, s81, s80
    s_add_u32 s81, s76, 2
    s_and_b32 s81, s81, 3
    s_mul_i32 s81, s81, 7168
    s_add_u32 s98, s81, s80
    s_add_u32 s81, s76, 3
    s_and_b32 s81, s81, 3
    s_mul_i32 s81, s81, 7168
    s_add_u32 s99, s81, s80
    s_mul_i32 s78, s7, 172032
    s_lshl_b32 s79, s7, 12
    s_add_u32 s79, s79, s9
    s_add_u32 m0, s79, 50304
    s_add_u32 s78, s78, s5
    buffer_load_dwordx4 v208, s[28:31], s78 offen offset:896 lds
    s_add_u32 m0, s79, 78080
    s_lshl_b32 s77, s7, 7
    buffer_load_dwordx4 v208, s[28:31], s78 offen offset:1792 lds
    s_add_u32 m0, s6, 4096
    s_add_u32 s77, s77, s4
    buffer_load_dwordx4 v204, s[24:27], s77 offen lds
    s_add_u32 m0, s6, 5120
    s_add_u32 s7, s7, 1
    s_cmp_eq_u32 s7, 7
    s_cselect_b32 s7, 0, s7
    buffer_load_dwordx4 v205, s[24:27], s77 offen lds
    s_add_u32 m0, s6, 6144
    s_nop 0
    buffer_load_dwordx4 v206, s[24:27], s77 offen lds
    s_add_u32 m0, s6, 7168
    s_nop 0
    buffer_load_dwordx4 v207, s[24:27], s77 offen lds
    s_lshl_b32 s80, s8, 12
    v_add_u32 v214, s80, v213
    v_add_u32 v215, s9, v214
    s_add_u32 s8, s8, 1
    s_cmp_eq_u32 s8, 7
    s_cselect_b32 s8, 0, s8
    s_waitcnt vmcnt(9)
    ds_read_b128 v[8:11], v209 offset:0
    ds_read_b128 v[12:15], v210 offset:0
    ds_read_b128 v[16:19], v211 offset:0
    ds_read_b128 v[20:23], v212 offset:0
    ds_read_b64_tr_b16 v[192:193], v215 offset:0
    ds_read_b64_tr_b16 v[194:195], v215 offset:256
    ds_read_b64_tr_b16 v[196:197], v215 offset:28672
    ds_read_b64_tr_b16 v[198:199], v215 offset:28928
    s_barrier
    ds_read_b64_tr_b16 v[168:169], v214 offset:0
    ds_read_b64_tr_b16 v[170:171], v214 offset:256
    ds_read_b64_tr_b16 v[172:173], v214 offset:28672
    ds_read_b64_tr_b16 v[174:175], v214 offset:28928
    ds_read_b64_tr_b16 v[176:177], v214 offset:1024
    ds_read_b64_tr_b16 v[178:179], v214 offset:1280
    ds_read_b64_tr_b16 v[180:181], v214 offset:29696
    ds_read_b64_tr_b16 v[182:183], v214 offset:29952
    ds_read_b64_tr_b16 v[184:185], v214 offset:2048
    ds_read_b64_tr_b16 v[186:187], v214 offset:2304
    ds_read_b64_tr_b16 v[188:189], v214 offset:30720
    ds_read_b64_tr_b16 v[190:191], v214 offset:30976
    s_waitcnt lgkmcnt(12)
    v_mfma_f32_32x32x16_bf16 a[224:239], v[200:203], v[192:195], 0
    s_mul_i32 s78, s7, 172032
    s_lshl_b32 s79, s7, 12
    s_add_u32 s79, s79, s9
    s_add_u32 m0, s79, 50304
    s_add_u32 s78, s78, s5
    buffer_load_dwordx4 v208, s[28:31], s78 offen offset:896 lds
    v_mfma_f32_32x32x16_bf16 a[240:255], v[200:203], v[196:199], 0
    s_add_u32 m0, s79, 78080
    s_lshl_b32 s77, s7, 7
    buffer_load_dwordx4 v208, s[28:31], s78 offen offset:1792 lds
    s_waitcnt lgkmcnt(8)
    v_mfma_f32_32x32x16_bf16 v[120:135], v[8:11], v[168:171], 0
    s_add_u32 m0, s6, 8192
    s_add_u32 s77, s77, s4
    buffer_load_dwordx4 v204, s[24:27], s77 offen lds
    v_mfma_f32_32x32x16_bf16 v[136:151], v[8:11], v[172:175], 0
    ds_read_b64_tr_b16 v[168:169], v214 offset:3072
    ds_read_b64_tr_b16 v[170:171], v214 offset:3328
    ds_read_b64_tr_b16 v[172:173], v214 offset:31744
    ds_read_b64_tr_b16 v[174:175], v214 offset:32000
    s_lshl_b32 s80, s8, 12
    v_add_u32 v214, s80, v213
    v_add_u32 v215, s9, v214
    s_add_u32 s8, s8, 1
    s_cmp_eq_u32 s8, 7
    s_cselect_b32 s8, 0, s8
    s_waitcnt lgkmcnt(8)
    v_mfma_f32_32x32x16_bf16 v[120:135], v[12:15], v[176:179], v[120:135]
    s_add_u32 m0, s6, 9216
    s_add_u32 s7, s7, 1
    s_cmp_eq_u32 s7, 7
    s_cselect_b32 s7, 0, s7
    buffer_load_dwordx4 v205, s[24:27], s77 offen lds
    v_mfma_f32_32x32x16_bf16 v[136:151], v[12:15], v[180:183], v[136:151]
    s_add_u32 m0, s6, 10240
    s_nop 0
    buffer_load_dwordx4 v206, s[24:27], s77 offen lds
    s_waitcnt lgkmcnt(4)
    v_mfma_f32_32x32x16_bf16 v[120:135], v[16:19], v[184:187], v[120:135]
    s_add_u32 m0, s6, 11264
    s_nop 0
    buffer_load_dwordx4 v207, s[24:27], s77 offen lds
    v_mfma_f32_32x32x16_bf16 v[136:151], v[16:19], v[188:191], v[136:151]
    s_waitcnt lgkmcnt(0)
    v_mfma_f32_32x32x16_bf16 v[120:135], v[20:23], v[168:171], v[120:135]
    v_mfma_f32_32x32x16_bf16 v[136:151], v[20:23], v[172:175], v[136:151]
    s_waitcnt vmcnt(6)
    ds_read_b128 v[24:27], v209 offset:4096
    ds_read_b128 v[28:31], v210 offset:4096
    ds_read_b128 v[32:35], v211 offset:4096
    ds_read_b128 v[36:39], v212 offset:4096
    ds_read_b64_tr_b16 v[192:193], v215 offset:0
    ds_read_b64_tr_b16 v[194:195], v215 offset:256
    ds_read_b64_tr_b16 v[196:197], v215 offset:28672
    ds_read_b64_tr_b16 v[198:199], v215 offset:28928
    s_barrier
    ds_read_b64_tr_b16 v[168:169], v214 offset:0
    ds_read_b64_tr_b16 v[170:171], v214 offset:256
    ds_read_b64_tr_b16 v[172:173], v214 offset:28672
    ds_read_b64_tr_b16 v[174:175], v214 offset:28928
    ds_read_b64_tr_b16 v[176:177], v214 offset:1024
    ds_read_b64_tr_b16 v[178:179], v214 offset:1280
    ds_read_b64_tr_b16 v[180:181], v214 offset:29696
    ds_read_b64_tr_b16 v[182:183], v214 offset:29952
    ds_read_b64_tr_b16 v[184:185], v214 offset:2048
    ds_read_b64_tr_b16 v[186:187], v214 offset:2304
    ds_read_b64_tr_b16 v[188:189], v214 offset:30720
    ds_read_b64_tr_b16 v[190:191], v214 offset:30976
    v_mov_b32 v5, 1
    s_lshl_b32 s81, s70, 2
    v_mov_b32 v6, s81
    s_mov_b64 exec, 1
    buffer_atomic_add v5, v6, s[64:67], 0 offen sc1
    s_mov_b64 exec, -1
    s_cmp_eq_u32 s68, 0
    s_cselect_b32 s62, 0x10000000, 0
    v_dot2c_f32_bf16 v216, s85, v8
    v_dot2c_f32_bf16 v218, v8, v8
    v_dot2c_f32_bf16 v217, s85, v9
    v_dot2c_f32_bf16 v219, v9, v9
    v_dot2c_f32_bf16 v216, s85, v10
    v_dot2c_f32_bf16 v218, v10, v10
    v_dot2c_f32_bf16 v217, s85, v11
    v_dot2c_f32_bf16 v219, v11, v11
    v_dot2c_f32_bf16 v216, s85, v12
    v_dot2c_f32_bf16 v218, v12, v12
    v_dot2c_f32_bf16 v217, s85, v13
    v_dot2c_f32_bf16 v219, v13, v13
    v_dot2c_f32_bf16 v216, s85, v14
    v_dot2c_f32_bf16 v218, v14, v14
    v_dot2c_f32_bf16 v217, s85, v15
    v_dot2c_f32_bf16 v219, v15, v15
    v_dot2c_f32_bf16 v216, s85, v16
    v_dot2c_f32_bf16 v218, v16, v16
    v_dot2c_f32_bf16 v217, s85, v17
    v_dot2c_f32_bf16 v219, v17, v17
    v_dot2c_f32_bf16 v216, s85, v18
    v_dot2c_f32_bf16 v218, v18, v18
    v_dot2c_f32_bf16 v217, s85, v19
    v_dot2c_f32_bf16 v219, v19, v19
    v_dot2c_f32_bf16 v216, s85, v20
    v_dot2c_f32_bf16 v218, v20, v20
    v_dot2c_f32_bf16 v217, s85, v21
    v_dot2c_f32_bf16 v219, v21, v21
    v_dot2c_f32_bf16 v216, s85, v22
    v_dot2c_f32_bf16 v218, v22, v22
    v_dot2c_f32_bf16 v217, s85, v23
    v_dot2c_f32_bf16 v219, v23, v23
    s_waitcnt lgkmcnt(12)
    v_mfma_f32_32x32x16_bf16 a[224:239], v[200:203], v[192:195], a[224:239]
    s_mul_i32 s78, s7, 172032
    s_lshl_b32 s79, s7, 12
    s_add_u32 s79, s79, s9
    s_add_u32 m0, s79, 50304
    s_add_u32 s78, s78, s5
    buffer_load_dwordx4 v208, s[28:31], s78 offen offset:896 lds
    v_mfma_f32_32x32x16_bf16 a[240:255], v[200:203], v[196:199], a[240:255]
    s_add_u32 m0, s79, 78080
    s_lshl_b32 s77, s7, 7
    buffer_load_dwordx4 v208, s[28:31], s78 offen offset:1792 lds
    s_waitcnt lgkmcnt(8)
    v_mfma_f32_32x32x16_bf16 v[120:135], v[24:27], v[168:171], v[120:135]
    s_add_u32 m0, s6, 0
    s_add_u32 s77, s77, s4
    buffer_load_dwordx4 v204, s[24:27], s77 offen lds
    v_mfma_f32_32x32x16_bf16 v[136:151], v[24:27], v[172:175], v[136:151]
    ds_read_b64_tr_b16 v[168:169], v214 offset:3072
    ds_read_b64_tr_b16 v[170:171], v214 offset:3328
    ds_read_b64_tr_b16 v[172:173], v214 offset:31744
    ds_read_b64_tr_b16 v[174:175], v214 offset:32000
    s_lshl_b32 s80, s8, 12
    v_add_u32 v214, s80, v213
    v_add_u32 v215, s9, v214
    s_add_u32 s8, s8, 1
    s_cmp_eq_u32 s8, 7
    s_cselect_b32 s8, 0, s8
    s_waitcnt lgkmcnt(8)
    v_mfma_f32_32x32x16_bf16 v[120:135], v[28:31], v[176:179], v[120:135]
    s_add_u32 m0, s6, 1024
    s_add_u32 s7, s7, 1
    s_cmp_eq_u32 s7, 7
    s_cselect_b32 s7, 0, s7
    buffer_load_dwordx4 v205, s[24:27], s77 offen lds
    v_mfma_f32_32x32x16_bf16 v[136:151], v[28:31], v[180:183], v[136:151]
    s_add_u32 m0, s6, 2048
    s_nop 0
    buffer_load_dwordx4 v206, s[24:27], s77 offen lds
    s_waitcnt lgkmcnt(4)
    v_mfma_f32_32x32x16_bf16 v[120:135], v[32:35], v[184:187], v[120:135]
    s_add_u32 m0, s6, 3072
    s_nop 0
    buffer_load_dwordx4 v207, s[24:27], s77 offen lds
    v_mfma_f32_32x32x16_bf16 v[136:151], v[32:35], v[188:191], v[136:151]
    s_waitcnt lgkmcnt(0)
    v_mfma_f32_32x32x16_bf16 v[120:135], v[36:39], v[168:171], v[120:135]
    v_mfma_f32_32x32x16_bf16 v[136:151], v[36:39], v[172:175], v[136:151]
    s_waitcnt vmcnt(7)
    ds_read_b128 v[40:43], v209 offset:8192
    ds_read_b128 v[44:47], v210 offset:8192
    ds_read_b128 v[48:51], v211 offset:8192
    ds_read_b128 v[52:55], v212 offset:8192
    ds_read_b64_tr_b16 v[192:193], v215 offset:0
    ds_read_b64_tr_b16 v[194:195], v215 offset:256
    ds_read_b64_tr_b16 v[196:197], v215 offset:28672
    ds_read_b64_tr_b16 v[198:199], v215 offset:28928
    s_barrier
    ds_read_b64_tr_b16 v[168:169], v214 offset:0
    ds_read_b64_tr_b16 v[170:171], v214 offset:256
    ds_read_b64_tr_b16 v[172:173], v214 offset:28672
    ds_read_b64_tr_b16 v[174:175], v214 offset:28928
    ds_read_b64_tr_b16 v[176:177], v214 offset:1024
    ds_read_b64_tr_b16 v[178:179], v214 offset:1280
    ds_read_b64_tr_b16 v[180:181], v214 offset:29696
    ds_read_b64_tr_b16 v[182:183], v214 offset:29952
    ds_read_b64_tr_b16 v[184:185], v214 offset:2048
    ds_read_b64_tr_b16 v[186:187], v214 offset:2304
    ds_read_b64_tr_b16 v[188:189], v214 offset:30720
    ds_read_b64_tr_b16 v[190:191], v214 offset:30976
    v_dot2c_f32_bf16 v216, s85, v24
    v_dot2c_f32_bf16 v218, v24, v24
    v_dot2c_f32_bf16 v217, s85, v25
    v_dot2c_f32_bf16 v219, v25, v25
    v_dot2c_f32_bf16 v216, s85, v26
    v_dot2c_f32_bf16 v218, v26, v26
    v_dot2c_f32_bf16 v217, s85, v27
    v_dot2c_f32_bf16 v219, v27, v27
    v_dot2c_f32_bf16 v216, s85, v28
    v_dot2c_f32_bf16 v218, v28, v28
    v_dot2c_f32_bf16 v217, s85, v29
    v_dot2c_f32_bf16 v219, v29, v29
    v_dot2c_f32_bf16 v216, s85, v30
    v_dot2c_f32_bf16 v218, v30, v30
    v_dot2c_f32_bf16 v217, s85, v31
    v_dot2c_f32_bf16 v219, v31, v31
    v_dot2c_f32_bf16 v216, s85, v32
    v_dot2c_f32_bf16 v218, v32, v32
    v_dot2c_f32_bf16 v217, s85, v33
    v_dot2c_f32_bf16 v219, v33, v33
    v_dot2c_f32_bf16 v216, s85, v34
    v_dot2c_f32_bf16 v218, v34, v34
    v_dot2c_f32_bf16 v217, s85, v35
    v_dot2c_f32_bf16 v219, v35, v35
    v_dot2c_f32_bf16 v216, s85, v36
    v_dot2c_f32_bf16 v218, v36, v36
    v_dot2c_f32_bf16 v217, s85, v37
    v_dot2c_f32_bf16 v219, v37, v37
    v_dot2c_f32_bf16 v216, s85, v38
    v_dot2c_f32_bf16 v218, v38, v38
    v_dot2c_f32_bf16 v217, s85, v39
    v_dot2c_f32_bf16 v219, v39, v39
    s_waitcnt lgkmcnt(12)
    v_mfma_f32_32x32x16_bf16 a[224:239], v[200:203], v[192:195], a[224:239]
    s_mul_i32 s78, s7, 172032
    s_lshl_b32 s79, s7, 12
    s_add_u32 s79, s79, s9
    s_add_u32 m0, s79, 50304
    s_add_u32 s78, s78, s5
    buffer_load_dwordx4 v208, s[28:31], s78 offen offset:896 lds
    v_mfma_f32_32x32x16_bf16 a[240:255], v[200:203], v[196:199], a[240:255]
    s_add_u32 m0, s79, 78080
    s_lshl_b32 s77, s7, 7
    buffer_load_dwordx4 v208, s[28:31], s78 offen offset:1792 lds
    s_waitcnt lgkmcnt(8)
    v_mfma_f32_32x32x16_bf16 v[120:135], v[40:43], v[168:171], v[120:135]
    s_add_u32 m0, s6, 4096
    s_add_u32 s77, s77, s4
    buffer_load_dwordx4 v204, s[24:27], s77 offen lds
    v_mfma_f32_32x32x16_bf16 v[136:151], v[40:43], v[172:175], v[136:151]
    ds_read_b64_tr_b16 v[168:169], v214 offset:3072
    ds_read_b64_tr_b16 v[170:171], v214 offset:3328
    ds_read_b64_tr_b16 v[172:173], v214 offset:31744
    ds_read_b64_tr_b16 v[174:175], v214 offset:32000
    s_lshl_b32 s80, s8, 12
    v_add_u32 v214, s80, v213
    v_add_u32 v215, s9, v214
    s_add_u32 s8, s8, 1
    s_cmp_eq_u32 s8, 7
    s_cselect_b32 s8, 0, s8
    s_waitcnt lgkmcnt(8)
    v_mfma_f32_32x32x16_bf16 v[120:135], v[44:47], v[176:179], v[120:135]
    s_add_u32 m0, s6, 5120
    s_add_u32 s7, s7, 1
    s_cmp_eq_u32 s7, 7
    s_cselect_b32 s7, 0, s7
    buffer_load_dwordx4 v205, s[24:27], s77 offen lds
    v_mfma_f32_32x32x16_bf16 v[136:151], v[44:47], v[180:183], v[136:151]
    s_add_u32 m0, s6, 6144
    s_nop 0
    buffer_load_dwordx4 v206, s[24:27], s77 offen lds
    s_waitcnt lgkmcnt(4)
    v_mfma_f32_32x32x16_bf16 v[120:135], v[48:51], v[184:187], v[120:135]
    s_add_u32 m0, s6, 7168
    s_nop 0
    buffer_load_dwordx4 v207, s[24:27], s77 offen lds
    v_mfma_f32_32x32x16_bf16 v[136:151], v[48:51], v[188:191], v[136:151]
    s_waitcnt lgkmcnt(0)
    v_mfma_f32_32x32x16_bf16 v[120:135], v[52:55], v[168:171], v[120:135]
    v_mfma_f32_32x32x16_bf16 v[136:151], v[52:55], v[172:175], v[136:151]
    s_waitcnt vmcnt(6)
    ds_read_b128 v[56:59], v209 offset:0
    ds_read_b128 v[60:63], v210 offset:0
    ds_read_b128 v[64:67], v211 offset:0
    ds_read_b128 v[68:71], v212 offset:0
    ds_read_b64_tr_b16 v[192:193], v215 offset:0
    ds_read_b64_tr_b16 v[194:195], v215 offset:256
    ds_read_b64_tr_b16 v[196:197], v215 offset:28672
    ds_read_b64_tr_b16 v[198:199], v215 offset:28928
    s_barrier
    ds_read_b64_tr_b16 v[168:169], v214 offset:0
    ds_read_b64_tr_b16 v[170:171], v214 offset:256
    ds_read_b64_tr_b16 v[172:173], v214 offset:28672
    ds_read_b64_tr_b16 v[174:175], v214 offset:28928
    ds_read_b64_tr_b16 v[176:177], v214 offset:1024
    ds_read_b64_tr_b16 v[178:179], v214 offset:1280
    ds_read_b64_tr_b16 v[180:181], v214 offset:29696
    ds_read_b64_tr_b16 v[182:183], v214 offset:29952
    ds_read_b64_tr_b16 v[184:185], v214 offset:2048
    ds_read_b64_tr_b16 v[186:187], v214 offset:2304
    ds_read_b64_tr_b16 v[188:189], v214 offset:30720
    ds_read_b64_tr_b16 v[190:191], v214 offset:30976
    v_dot2c_f32_bf16 v216, s85, v40
    v_dot2c_f32_bf16 v218, v40, v40
    v_dot2c_f32_bf16 v217, s85, v41
    v_dot2c_f32_bf16 v219, v41, v41
    v_dot2c_f32_bf16 v216, s85, v42
    v_dot2c_f32_bf16 v218, v42, v42
    v_dot2c_f32_bf16 v217, s85, v43
    v_dot2c_f32_bf16 v219, v43, v43
    v_dot2c_f32_bf16 v216, s85, v44
    v_dot2c_f32_bf16 v218, v44, v44
    v_dot2c_f32_bf16 v217, s85, v45
    v_dot2c_f32_bf16 v219, v45, v45
    v_dot2c_f32_bf16 v216, s85, v46
    v_dot2c_f32_bf16 v218, v46, v46
    v_dot2c_f32_bf16 v217, s85, v47
    v_dot2c_f32_bf16 v219, v47, v47
    v_dot2c_f32_bf16 v216, s85, v48
    v_dot2c_f32_bf16 v218, v48, v48
    v_dot2c_f32_bf16 v217, s85, v49
    v_dot2c_f32_bf16 v219, v49, v49
    v_dot2c_f32_bf16 v216, s85, v50
    v_dot2c_f32_bf16 v218, v50, v50
    v_dot2c_f32_bf16 v217, s85, v51
    v_dot2c_f32_bf16 v219, v51, v51
    v_dot2c_f32_bf16 v216, s85, v52
    v_dot2c_f32_bf16 v218, v52, v52
    v_dot2c_f32_bf16 v217, s85, v53
    v_dot2c_f32_bf16 v219, v53, v53
    v_dot2c_f32_bf16 v216, s85, v54
    v_dot2c_f32_bf16 v218, v54, v54
    v_dot2c_f32_bf16 v217, s85, v55
    v_dot2c_f32_bf16 v219, v55, v55
    s_waitcnt lgkmcnt(12)
    v_mfma_f32_32x32x16_bf16 a[224:239], v[200:203], v[192:195], a[224:239]
    s_mul_i32 s78, s7, 172032
    s_lshl_b32 s79, s7, 12
    s_add_u32 s79, s79, s9
    s_add_u32 m0, s79, 50304
    s_add_u32 s78, s78, s5
    buffer_load_dwordx4 v208, s[28:31], s78 offen offset:896 lds
    v_mfma_f32_32x32x16_bf16 a[240:255], v[200:203], v[196:199], a[240:255]
    s_add_u32 m0, s79, 78080
    s_lshl_b32 s77, s7, 7
    buffer_load_dwordx4 v208, s[28:31], s78 offen offset:1792 lds
    s_waitcnt lgkmcnt(8)
    v_mfma_f32_32x32x16_bf16 v[120:135], v[56:59], v[168:171], v[120:135]
    s_add_u32 m0, s6, 8192
    s_add_u32 s77, s77, s4
    buffer_load_dwordx4 v204, s[24:27], s77 offen lds
    v_mfma_f32_32x32x16_bf16 v[136:151], v[56:59], v[172:175], v[136:151]
    ds_read_b64_tr_b16 v[168:169], v214 offset:3072
    ds_read_b64_tr_b16 v[170:171], v214 offset:3328
    ds_read_b64_tr_b16 v[172:173], v214 offset:31744
    ds_read_b64_tr_b16 v[174:175], v214 offset:32000
    s_lshl_b32 s80, s8, 12
    v_add_u32 v214, s80, v213
    v_add_u32 v215, s9, v214
    s_add_u32 s8, s8, 1
    s_cmp_eq_u32 s8, 7
    s_cselect_b32 s8, 0, s8
    s_waitcnt lgkmcnt(8)
    v_mfma_f32_32x32x16_bf16 v[120:135], v[60:63], v[176:179], v[120:135]
    s_add_u32 m0, s6, 9216
    s_add_u32 s7, s7, 1
    s_cmp_eq_u32 s7, 7
    s_cselect_b32 s7, 0, s7
    buffer_load_dwordx4 v205, s[24:27], s77 offen lds
    v_mfma_f32_32x32x16_bf16 v[136:151], v[60:63], v[180:183], v[136:151]
    s_add_u32 m0, s6, 10240
    s_nop 0
    buffer_load_dwordx4 v206, s[24:27], s77 offen lds
    s_waitcnt lgkmcnt(4)
    v_mfma_f32_32x32x16_bf16 v[120:135], v[64:67], v[184:187], v[120:135]
    s_add_u32 m0, s6, 11264
    s_nop 0
    buffer_load_dwordx4 v207, s[24:27], s77 offen lds
    v_mfma_f32_32x32x16_bf16 v[136:151], v[64:67], v[188:191], v[136:151]
    v_lshlrev_b32 v249, 2, v1
    buffer_load_dword v248, v249, s[52:55], 0 offen sc1
    s_waitcnt lgkmcnt(0)
    v_mfma_f32_32x32x16_bf16 v[120:135], v[68:71], v[168:171], v[120:135]
    v_mfma_f32_32x32x16_bf16 v[136:151], v[68:71], v[172:175], v[136:151]
    s_waitcnt vmcnt(7)
    ds_read_b128 v[72:75], v209 offset:4096
    ds_read_b128 v[76:79], v210 offset:4096
    ds_read_b128 v[80:83], v211 offset:4096
    ds_read_b128 v[84:87], v212 offset:4096
    ds_read_b64_tr_b16 v[192:193], v215 offset:0
    ds_read_b64_tr_b16 v[194:195], v215 offset:256
    ds_read_b64_tr_b16 v[196:197], v215 offset:28672
    ds_read_b64_tr_b16 v[198:199], v215 offset:28928
    s_barrier
    ds_read_b64_tr_b16 v[168:169], v214 offset:0
    ds_read_b64_tr_b16 v[170:171], v214 offset:256
    ds_read_b64_tr_b16 v[172:173], v214 offset:28672
    ds_read_b64_tr_b16 v[174:175], v214 offset:28928
    ds_read_b64_tr_b16 v[176:177], v214 offset:1024
    ds_read_b64_tr_b16 v[178:179], v214 offset:1280
    ds_read_b64_tr_b16 v[180:181], v214 offset:29696
    ds_read_b64_tr_b16 v[182:183], v214 offset:29952
    ds_read_b64_tr_b16 v[184:185], v214 offset:2048
    ds_read_b64_tr_b16 v[186:187], v214 offset:2304
    ds_read_b64_tr_b16 v[188:189], v214 offset:30720
    ds_read_b64_tr_b16 v[190:191], v214 offset:30976
    v_dot2c_f32_bf16 v216, s85, v56
    v_dot2c_f32_bf16 v218, v56, v56
    v_dot2c_f32_bf16 v217, s85, v57
    v_dot2c_f32_bf16 v219, v57, v57
    v_dot2c_f32_bf16 v216, s85, v58
    v_dot2c_f32_bf16 v218, v58, v58
    v_dot2c_f32_bf16 v217, s85, v59
    v_dot2c_f32_bf16 v219, v59, v59
    v_dot2c_f32_bf16 v216, s85, v60
    v_dot2c_f32_bf16 v218, v60, v60
    v_dot2c_f32_bf16 v217, s85, v61
    v_dot2c_f32_bf16 v219, v61, v61
    v_dot2c_f32_bf16 v216, s85, v62
    v_dot2c_f32_bf16 v218, v62, v62
    v_dot2c_f32_bf16 v217, s85, v63
    v_dot2c_f32_bf16 v219, v63, v63
    v_dot2c_f32_bf16 v216, s85, v64
    v_dot2c_f32_bf16 v218, v64, v64
    v_dot2c_f32_bf16 v217, s85, v65
    v_dot2c_f32_bf16 v219, v65, v65
    v_dot2c_f32_bf16 v216, s85, v66
    v_dot2c_f32_bf16 v218, v66, v66
    v_dot2c_f32_bf16 v217, s85, v67
    v_dot2c_f32_bf16 v219, v67, v67
    v_dot2c_f32_bf16 v216, s85, v68
    v_dot2c_f32_bf16 v218, v68, v68
    v_dot2c_f32_bf16 v217, s85, v69
    v_dot2c_f32_bf16 v219, v69, v69
    v_dot2c_f32_bf16 v216, s85, v70
    v_dot2c_f32_bf16 v218, v70, v70
    v_dot2c_f32_bf16 v217, s85, v71
    v_dot2c_f32_bf16 v219, v71, v71
    s_waitcnt lgkmcnt(12)
    v_mfma_f32_32x32x16_bf16 a[224:239], v[200:203], v[192:195], a[224:239]
    s_mul_i32 s78, s7, 172032
    s_lshl_b32 s79, s7, 12
    s_add_u32 s79, s79, s9
    s_add_u32 m0, s79, 50304
    s_add_u32 s78, s78, s5
    buffer_load_dwordx4 v208, s[28:31], s78 offen offset:896 lds
    v_mfma_f32_32x32x16_bf16 a[240:255], v[200:203], v[196:199], a[240:255]
    s_add_u32 m0, s79, 78080
    s_lshl_b32 s77, s7, 7
    buffer_load_dwordx4 v208, s[28:31], s78 offen offset:1792 lds
    s_waitcnt lgkmcnt(8)
    v_mfma_f32_32x32x16_bf16 v[120:135], v[72:75], v[168:171], v[120:135]
    s_add_u32 m0, s6, 0
    s_add_u32 s77, s77, s4
    buffer_load_dwordx4 v204, s[24:27], s77 offen lds
    v_mfma_f32_32x32x16_bf16 v[136:151], v[72:75], v[172:175], v[136:151]
    ds_read_b64_tr_b16 v[168:169], v214 offset:3072
    ds_read_b64_tr_b16 v[170:171], v214 offset:3328
    ds_read_b64_tr_b16 v[172:173], v214 offset:31744
    ds_read_b64_tr_b16 v[174:175], v214 offset:32000
    s_lshl_b32 s80, s8, 12
    v_add_u32 v214, s80, v213
    v_add_u32 v215, s9, v214
    s_add_u32 s8, s8, 1
    s_cmp_eq_u32 s8, 7
    s_cselect_b32 s8, 0, s8
    s_waitcnt lgkmcnt(8)
    v_mfma_f32_32x32x16_bf16 v[120:135], v[76:79], v[176:179], v[120:135]
    s_add_u32 m0, s6, 1024
    s_add_u32 s7, s7, 1
    s_cmp_eq_u32 s7, 7
    s_cselect_b32 s7, 0, s7
    buffer_load_dwordx4 v205, s[24:27], s77 offen lds
    v_mfma_f32_32x32x16_bf16 v[136:151], v[76:79], v[180:183], v[136:151]
    s_add_u32 m0, s6, 2048
    s_nop 0
    buffer_load_dwordx4 v206, s[24:27], s77 offen lds
    s_waitcnt lgkmcnt(4)
    v_mfma_f32_32x32x16_bf16 v[120:135], v[80:83], v[184:187], v[120:135]
    s_add_u32 m0, s6, 3072
    s_nop 0
    buffer_load_dwordx4 v207, s[24:27], s77 offen lds
    v_mfma_f32_32x32x16_bf16 v[136:151], v[80:83], v[188:191], v[136:151]
    s_add_u32 m0, s95, 0
    s_nop 0
    buffer_load_dwordx4 v236, s[32:35], s11 offen lds
    s_waitcnt lgkmcnt(0)
    v_mfma_f32_32x32x16_bf16 v[120:135], v[84:87], v[168:171], v[120:135]
    s_add_u32 m0, s95, 1024
    s_nop 0
    buffer_load_dwordx4 v236, s[32:35], s12 offen lds
    v_mfma_f32_32x32x16_bf16 v[136:151], v[84:87], v[172:175], v[136:151]
    s_add_u32 m0, s95, 2048
    s_nop 0
    buffer_load_dwordx4 v236, s[36:39], s13 offen lds
    s_add_u32 m0, s95, 3072
    s_nop 0
    buffer_load_dwordx4 v236, s[36:39], s14 offen lds
    s_waitcnt vmcnt(11)
    ds_read_b128 v[88:91], v209 offset:8192
    ds_read_b128 v[92:95], v210 offset:8192
    ds_read_b128 v[96:99], v211 offset:8192
    ds_read_b128 v[100:103], v212 offset:8192
    ds_read_b64_tr_b16 v[192:193], v215 offset:0
    ds_read_b64_tr_b16 v[194:195], v215 offset:256
    ds_read_b64_tr_b16 v[196:197], v215 offset:28672
    ds_read_b64_tr_b16 v[198:199], v215 offset:28928
    s_barrier
    ds_read_b64_tr_b16 v[168:169], v214 offset:0
    ds_read_b64_tr_b16 v[170:171], v214 offset:256
    ds_read_b64_tr_b16 v[172:173], v214 offset:28672
    ds_read_b64_tr_b16 v[174:175], v214 offset:28928
    ds_read_b64_tr_b16 v[176:177], v214 offset:1024
    ds_read_b64_tr_b16 v[178:179], v214 offset:1280
    ds_read_b64_tr_b16 v[180:181], v214 offset:29696
    ds_read_b64_tr_b16 v[182:183], v214 offset:29952
    ds_read_b64_tr_b16 v[184:185], v214 offset:2048
    ds_read_b64_tr_b16 v[186:187], v214 offset:2304
    ds_read_b64_tr_b16 v[188:189], v214 offset:30720
    ds_read_b64_tr_b16 v[190:191], v214 offset:30976
    v_dot2c_f32_bf16 v216, s85, v72
    v_dot2c_f32_bf16 v218, v72, v72
    v_dot2c_f32_bf16 v217, s85, v73
    v_dot2c_f32_bf16 v219, v73, v73
    v_dot2c_f32_bf16 v216, s85, v74
    v_dot2c_f32_bf16 v218, v74, v74
    v_dot2c_f32_bf16 v217, s85, v75
    v_dot2c_f32_bf16 v219, v75, v75
    v_dot2c_f32_bf16 v216, s85, v76
    v_dot2c_f32_bf16 v218, v76, v76
    v_dot2c_f32_bf16 v217, s85, v77
    v_dot2c_f32_bf16 v219, v77, v77
    v_dot2c_f32_bf16 v216, s85, v78
    v_dot2c_f32_bf16 v218, v78, v78
    v_dot2c_f32_bf16 v217, s85, v79
    v_dot2c_f32_bf16 v219, v79, v79
    v_dot2c_f32_bf16 v216, s85, v80
    v_dot2c_f32_bf16 v218, v80, v80
    v_dot2c_f32_bf16 v217, s85, v81
    v_dot2c_f32_bf16 v219, v81, v81
    v_dot2c_f32_bf16 v216, s85, v82
    v_dot2c_f32_bf16 v218, v82, v82
    v_dot2c_f32_bf16 v217, s85, v83
    v_dot2c_f32_bf16 v219, v83, v83
    v_dot2c_f32_bf16 v216, s85, v84
    v_dot2c_f32_bf16 v218, v84, v84
    v_dot2c_f32_bf16 v217, s85, v85
    v_dot2c_f32_bf16 v219, v85, v85
    v_dot2c_f32_bf16 v216, s85, v86
    v_dot2c_f32_bf16 v218, v86, v86
    v_dot2c_f32_bf16 v217, s85, v87
    v_dot2c_f32_bf16 v219, v87, v87
    s_waitcnt lgkmcnt(12)
    v_mfma_f32_32x32x16_bf16 a[224:239], v[200:203], v[192:195], a[224:239]
    s_mul_i32 s78, s7, 172032
    s_lshl_b32 s79, s7, 12
    s_add_u32 s79, s79, s9
    s_add_u32 m0, s79, 0
    s_add_u32 s78, s78, s5
    buffer_load_dwordx4 v208, s[28:31], s78 offen lds
    s_add_u32 s7, s7, 1
    s_cmp_eq_u32 s7, 7
    s_cselect_b32 s7, 0, s7
    v_mfma_f32_32x32x16_bf16 a[240:255], v[200:203], v[196:199], a[240:255]
    s_mul_i32 s78, s7, 172032
    s_lshl_b32 s79, s7, 12
    s_add_u32 s79, s79, s9
    s_add_u32 m0, s79, 0
    s_add_u32 s78, s78, s5
    buffer_load_dwordx4 v208, s[28:31], s78 offen lds
    s_add_u32 s7, s7, 1
    s_cmp_eq_u32 s7, 7
    s_cselect_b32 s7, 0, s7
    s_waitcnt lgkmcnt(8)
    v_mfma_f32_32x32x16_bf16 v[120:135], v[88:91], v[168:171], v[120:135]
    s_mul_i32 s78, s7, 172032
    s_lshl_b32 s79, s7, 12
    s_add_u32 s79, s79, s9
    s_add_u32 m0, s79, 0
    s_add_u32 s78, s78, s5
    buffer_load_dwordx4 v208, s[28:31], s78 offen lds
    s_add_u32 s7, s7, 1
    s_cmp_eq_u32 s7, 7
    s_cselect_b32 s7, 0, s7
    v_mfma_f32_32x32x16_bf16 v[136:151], v[88:91], v[172:175], v[136:151]
    ds_read_b64_tr_b16 v[168:169], v214 offset:3072
    ds_read_b64_tr_b16 v[170:171], v214 offset:3328
    ds_read_b64_tr_b16 v[172:173], v214 offset:31744
    ds_read_b64_tr_b16 v[174:175], v214 offset:32000
    s_lshl_b32 s80, s8, 12
    v_add_u32 v214, s80, v213
    v_add_u32 v215, s9, v214
    s_add_u32 s8, s8, 1
    s_cmp_eq_u32 s8, 7
    s_cselect_b32 s8, 0, s8
    s_waitcnt lgkmcnt(8)
    v_mfma_f32_32x32x16_bf16 v[120:135], v[92:95], v[176:179], v[120:135]
    s_mul_i32 s78, s7, 172032
    s_lshl_b32 s79, s7, 12
    s_add_u32 s79, s79, s9
    s_add_u32 m0, s79, 0
    s_add_u32 s78, s78, s5
    buffer_load_dwordx4 v208, s[28:31], s78 offen lds
    s_add_u32 s7, s7, 1
    s_cmp_eq_u32 s7, 7
    s_cselect_b32 s7, 0, s7
    v_mfma_f32_32x32x16_bf16 v[136:151], v[92:95], v[180:183], v[136:151]
    s_mul_i32 s78, s7, 172032
    s_lshl_b32 s79, s7, 12
    s_add_u32 s79, s79, s9
    s_add_u32 m0, s79, 0
    s_add_u32 s78, s78, s5
    buffer_load_dwordx4 v208, s[28:31], s78 offen lds
    s_add_u32 s7, s7, 1
    s_cmp_eq_u32 s7, 7
    s_cselect_b32 s7, 0, s7
    s_waitcnt lgkmcnt(4)
    v_mfma_f32_32x32x16_bf16 v[120:135], v[96:99], v[184:187], v[120:135]
    s_mul_i32 s78, s7, 172032
    s_lshl_b32 s79, s7, 12
    s_add_u32 s79, s79, s9
    s_add_u32 m0, s79, 0
    s_add_u32 s78, s78, s5
    buffer_load_dwordx4 v208, s[28:31], s78 offen lds
    s_add_u32 s7, s7, 1
    s_cmp_eq_u32 s7, 7
    s_cselect_b32 s7, 0, s7
    v_mfma_f32_32x32x16_bf16 v[136:151], v[96:99], v[188:191], v[136:151]
    s_mul_i32 s78, s7, 172032
    s_lshl_b32 s79, s7, 12
    s_add_u32 s79, s79, s9
    s_add_u32 m0, s79, 0
    s_add_u32 s78, s78, s5
    buffer_load_dwordx4 v208, s[28:31], s78 offen lds
    s_add_u32 s7, s7, 1
    s_cmp_eq_u32 s7, 7
    s_cselect_b32 s7, 0, s7
    s_waitcnt lgkmcnt(0)
    v_mfma_f32_32x32x16_bf16 v[120:135], v[100:103], v[168:171], v[120:135]
    v_mfma_f32_32x32x16_bf16 v[136:151], v[100:103], v[172:175], v[136:151]
    s_waitcnt vmcnt(11)
    ds_read_b128 v[104:107], v209 offset:0
    ds_read_b128 v[108:111], v210 offset:0
    ds_read_b128 v[112:115], v211 offset:0
    ds_read_b128 v[116:119], v212 offset:0
    ds_read_b64_tr_b16 v[192:193], v215 offset:0
    ds_read_b64_tr_b16 v[194:195], v215 offset:256
    ds_read_b64_tr_b16 v[196:197], v215 offset:28672
    ds_read_b64_tr_b16 v[198:199], v215 offset:28928
    s_barrier
    ds_read_b64_tr_b16 v[168:169], v214 offset:0
    ds_read_b64_tr_b16 v[170:171], v214 offset:256
    ds_read_b64_tr_b16 v[172:173], v214 offset:28672
    ds_read_b64_tr_b16 v[174:175], v214 offset:28928
    ds_read_b64_tr_b16 v[176:177], v214 offset:1024
    ds_read_b64_tr_b16 v[178:179], v214 offset:1280
    ds_read_b64_tr_b16 v[180:181], v214 offset:29696
    ds_read_b64_tr_b16 v[182:183], v214 offset:29952
    ds_read_b64_tr_b16 v[184:185], v214 offset:2048
    ds_read_b64_tr_b16 v[186:187], v214 offset:2304
    ds_read_b64_tr_b16 v[188:189], v214 offset:30720
    ds_read_b64_tr_b16 v[190:191], v214 offset:30976
    v_dot2c_f32_bf16 v216, s85, v88
    v_dot2c_f32_bf16 v218, v88, v88
    v_dot2c_f32_bf16 v217, s85, v89
    v_dot2c_f32_bf16 v219, v89, v89
    v_dot2c_f32_bf16 v216, s85, v90
    v_dot2c_f32_bf16 v218, v90, v90
    v_dot2c_f32_bf16 v217, s85, v91
    v_dot2c_f32_bf16 v219, v91, v91
    v_dot2c_f32_bf16 v216, s85, v92
    v_dot2c_f32_bf16 v218, v92, v92
    v_dot2c_f32_bf16 v217, s85, v93
    v_dot2c_f32_bf16 v219, v93, v93
    v_dot2c_f32_bf16 v216, s85, v94
    v_dot2c_f32_bf16 v218, v94, v94
    v_dot2c_f32_bf16 v217, s85, v95
    v_dot2c_f32_bf16 v219, v95, v95
    v_dot2c_f32_bf16 v216, s85, v96
    v_dot2c_f32_bf16 v218, v96, v96
    v_dot2c_f32_bf16 v217, s85, v97
    v_dot2c_f32_bf16 v219, v97, v97
    v_dot2c_f32_bf16 v216, s85, v98
    v_dot2c_f32_bf16 v218, v98, v98
    v_dot2c_f32_bf16 v217, s85, v99
    v_dot2c_f32_bf16 v219, v99, v99
    v_dot2c_f32_bf16 v216, s85, v100
    v_dot2c_f32_bf16 v218, v100, v100
    v_dot2c_f32_bf16 v217, s85, v101
    v_dot2c_f32_bf16 v219, v101, v101
    v_dot2c_f32_bf16 v216, s85, v102
    v_dot2c_f32_bf16 v218, v102, v102
    v_dot2c_f32_bf16 v217, s85, v103
    v_dot2c_f32_bf16 v219, v103, v103
    s_waitcnt lgkmcnt(15)
    v_dot2c_f32_bf16 v216, s85, v104
    v_dot2c_f32_bf16 v218, v104, v104
    v_dot2c_f32_bf16 v217, s85, v105
    v_dot2c_f32_bf16 v219, v105, v105
    v_dot2c_f32_bf16 v216, s85, v106
    v_dot2c_f32_bf16 v218, v106, v106
    v_dot2c_f32_bf16 v217, s85, v107
    v_dot2c_f32_bf16 v219, v107, v107
    v_dot2c_f32_bf16 v216, s85, v108
    v_dot2c_f32_bf16 v218, v108, v108
    v_dot2c_f32_bf16 v217, s85, v109
    v_dot2c_f32_bf16 v219, v109, v109
    v_dot2c_f32_bf16 v216, s85, v110
    v_dot2c_f32_bf16 v218, v110, v110
    v_dot2c_f32_bf16 v217, s85, v111
    v_dot2c_f32_bf16 v219, v111, v111
    v_dot2c_f32_bf16 v216, s85, v112
    v_dot2c_f32_bf16 v218, v112, v112
    v_dot2c_f32_bf16 v217, s85, v113
    v_dot2c_f32_bf16 v219, v113, v113
    v_dot2c_f32_bf16 v216, s85, v114
    v_dot2c_f32_bf16 v218, v114, v114
    v_dot2c_f32_bf16 v217, s85, v115
    v_dot2c_f32_bf16 v219, v115, v115
    v_dot2c_f32_bf16 v216, s85, v116
    v_dot2c_f32_bf16 v218, v116, v116
    v_dot2c_f32_bf16 v217, s85, v117
    v_dot2c_f32_bf16 v219, v117, v117
    v_dot2c_f32_bf16 v216, s85, v118
    v_dot2c_f32_bf16 v218, v118, v118
    v_dot2c_f32_bf16 v217, s85, v119
    v_dot2c_f32_bf16 v219, v119, v119
    s_waitcnt lgkmcnt(12)
    v_mfma_f32_32x32x16_bf16 a[224:239], v[200:203], v[192:195], a[224:239]
    v_add_f32 v216, v216, v217
    v_add_f32 v218, v218, v219
    v_mov_b32 v217, v216
    v_mov_b32 v219, v218
    v_mfma_f32_32x32x16_bf16 a[240:255], v[200:203], v[196:199], a[240:255]
    s_lshl_b32 s80, s68, 8
    s_add_u32 s80, s80, 28672
    v_permlane32_swap_b32 v216, v217
    v_permlane32_swap_b32 v218, v219
    s_waitcnt lgkmcnt(8)
    v_mfma_f32_32x32x16_bf16 v[120:135], v[104:107], v[168:171], v[120:135]
    v_add_f32 v216, v216, v217
    v_add_f32 v218, v218, v219
    v_mul_f32 v2, 0x3b124925, v216
    v_mul_f32 v3, 0x3b124925, v218
    v_mfma_f32_32x32x16_bf16 v[136:151], v[104:107], v[172:175], v[136:151]
    ds_read_b64_tr_b16 v[168:169], v214 offset:3072
    ds_read_b64_tr_b16 v[170:171], v214 offset:3328
    ds_read_b64_tr_b16 v[172:173], v214 offset:31744
    ds_read_b64_tr_b16 v[174:175], v214 offset:32000
    s_waitcnt lgkmcnt(8)
    v_mfma_f32_32x32x16_bf16 v[120:135], v[108:111], v[176:179], v[120:135]
    v_fma_f32 v3, -v2, v2, v3
    v_max_f32 v3, 0, v3
    v_cvt_pk_bf16_f32 v4, v2, v2
    v_and_b32 v4, 0xffff0000, v4
    v_mfma_f32_32x32x16_bf16 v[136:151], v[108:111], v[180:183], v[136:151]
    v_cvt_pk_bf16_f32 v3, v3, v3
    v_and_b32 v3, 0xffff0000, v3
    v_add_f32 v3, 0x3727c5ac, v3
    v_cvt_pk_bf16_f32 v3, v3, v3
    s_waitcnt lgkmcnt(4)
    v_mfma_f32_32x32x16_bf16 v[120:135], v[112:115], v[184:187], v[120:135]
    v_and_b32 v3, 0xffff0000, v3
    v_sqrt_f32 v3, v3
    s_nop 0
    v_cvt_pk_bf16_f32 v3, v3, v3
    v_and_b32 v3, 0xffff0000, v3
    v_mfma_f32_32x32x16_bf16 v[136:151], v[112:115], v[188:191], v[136:151]
    v_rcp_f32 v220, v3
    v_sub_f32 v221, 0, v4
    v_add_u32 v2, s80, v224
    ds_write_b32 v2, v220
    s_waitcnt lgkmcnt(1)
    v_mfma_f32_32x32x16_bf16 v[120:135], v[116:119], v[168:171], v[120:135]
    ds_write_b32 v2, v221 offset:128
    ds_write_b32 v225, a224
    ds_write_b32 v225, a240 offset:512
    v_add_u32 v5, 29696, v224
    v_mfma_f32_32x32x16_bf16 v[136:151], v[116:119], v[172:175], v[136:151]
    s_waitcnt lgkmcnt(0)
    s_barrier
    ds_read_b32 v152, v5 offset:0
    ds_read_b32 v153, v5 offset:128
    ds_read_b32 v154, v5 offset:256
    ds_read_b32 v155, v5 offset:384
    ds_read_b32 v156, v5 offset:512
    ds_read_b32 v157, v5 offset:640
    ds_read_b32 v158, v5 offset:768
    ds_read_b32 v159, v5 offset:896
    ds_read_b128 v[184:187], v226 offset:128
    ds_read_b128 v[188:191], v226 offset:160
    ds_read_b128 v[192:195], v226 offset:192
    ds_read_b128 v[196:199], v226 offset:224
    ds_read_b128 v[168:171], v226 offset:0
    ds_read_b128 v[172:175], v226 offset:32
    ds_read_b128 v[176:179], v226 offset:64
    ds_read_b128 v[180:183], v226 offset:96
    s_mov_b32 s94, 0
    s_waitcnt vmcnt(17)
    s_branch kf_pz_chk
kf_pz:
    buffer_load_dword v248, v249, s[52:55], 0 offen sc1
    s_add_u32 s94, s94, 1
    s_waitcnt vmcnt(0)
kf_pz_chk:
    v_cmp_le_u32 vcc, 4, v248
    s_cmp_ge_u32 s94, 524288
    s_nop 3
    s_cbranch_scc1 kf_pz_ok
    s_and_b32 s84, vcc_lo, 65535
    s_cmp_eq_u32 s84, 65535
    s_cbranch_scc1 kf_pz_ok
    s_sleep 1
    s_branch kf_pz
kf_pz_ok:
    s_waitcnt vmcnt(7)
    ds_read_b64_tr_b16 a[0:1], v232 offset:0
    ds_read_b64_tr_b16 a[2:3], v232 offset:512
    ds_read_b64_tr_b16 a[4:5], v233 offset:0
    ds_read_b64_tr_b16 a[6:7], v233 offset:512
    ds_read_b64_tr_b16 a[8:9], v234 offset:0
    ds_read_b64_tr_b16 a[10:11], v234 offset:512
    ds_read_b64_tr_b16 a[12:13], v235 offset:0
    ds_read_b64_tr_b16 a[14:15], v235 offset:512
    v_and_b32 v3, 31, v1
    v_mul_u32_u24 v3, 144, v3
    v_lshrrev_b32 v4, 5, v1
    v_lshl_add_u32 v3, v4, 4, v3
    v_add_u32 v206, s95, v3
    v_bfe_u32 v5, v1, 2, 2
    v_lshl_add_u32 v4, v4, 2, v5
    v_bfe_u32 v5, v1, 4, 1
    v_mul_u32_u24 v5, 14, v5
    v_add_u32 v5, v5, v4
    v_and_b32 v6, 3, v1
    v_lshlrev_b32 v6, 2, v6
    s_lshl_b32 s81, s68, 5
    s_add_u32 s81, s81, 32768
    v_add_u32 v6, s81, v6
    v_mul_u32_u24 v7, 144, v5
    v_add_u32 v204, v7, v6
    v_add_u32 v205, 1152, v204
    v_mul_u32_u24 v7, 144, v4
    v_add_u32 v7, v7, v6
    v_add_u32 v7, 3168, v7
    v_cmp_lt_u32 vcc, 5, v4
    s_nop 1
    v_cndmask_b32 v205, v205, v7, vcc
    s_waitcnt lgkmcnt(0)
    buffer_store_dwordx4 a[0:3], v240, s[40:43], s15 offen sc1
    buffer_store_dwordx4 a[4:7], v240, s[40:43], s16 offen sc1
    buffer_store_dwordx4 a[8:11], v240, s[40:43], s17 offen sc1
    buffer_store_dwordx4 a[12:15], v240, s[40:43], s18 offen sc1
    v_mfma_f32_32x32x16_bf16 a[32:47], v[200:203], a[0:3], 0
    v_mfma_f32_32x32x16_bf16 a[48:63], v[200:203], a[4:7], 0
    v_mfma_f32_32x32x16_bf16 a[64:79], v[200:203], a[8:11], 0
    v_mfma_f32_32x32x16_bf16 a[80:95], v[200:203], a[12:15], 0
    s_waitcnt lgkmcnt(15)
    v_add_f32 v152, v152, v153
    v_add_f32 v154, v154, v155
    v_add_f32 v222, v152, v154
    v_add_f32 v156, v156, v157
    v_add_f32 v158, v158, v159
    v_add_f32 v223, v156, v158
    s_waitcnt lgkmcnt(12)
    v_pk_fma_f32 v[120:121], v[184:185], v[222:223], v[120:121] op_sel_hi:[1,0,1]
    v_pk_fma_f32 v[136:137], v[184:185], v[222:223], v[136:137] op_sel:[0,1,0] op_sel_hi:[1,1,1]
    v_pk_fma_f32 v[122:123], v[186:187], v[222:223], v[122:123] op_sel_hi:[1,0,1]
    v_pk_fma_f32 v[138:139], v[186:187], v[222:223], v[138:139] op_sel:[0,1,0] op_sel_hi:[1,1,1]
    v_pk_fma_f32 v[124:125], v[188:189], v[222:223], v[124:125] op_sel_hi:[1,0,1]
    v_pk_fma_f32 v[140:141], v[188:189], v[222:223], v[140:141] op_sel:[0,1,0] op_sel_hi:[1,1,1]
    v_pk_fma_f32 v[126:127], v[190:191], v[222:223], v[126:127] op_sel_hi:[1,0,1]
    v_pk_fma_f32 v[142:143], v[190:191], v[222:223], v[142:143] op_sel:[0,1,0] op_sel_hi:[1,1,1]
    v_pk_fma_f32 v[128:129], v[192:193], v[222:223], v[128:129] op_sel_hi:[1,0,1]
    v_pk_fma_f32 v[144:145], v[192:193], v[222:223], v[144:145] op_sel:[0,1,0] op_sel_hi:[1,1,1]
    v_pk_fma_f32 v[130:131], v[194:195], v[222:223], v[130:131] op_sel_hi:[1,0,1]
    v_pk_fma_f32 v[146:147], v[194:195], v[222:223], v[146:147] op_sel:[0,1,0] op_sel_hi:[1,1,1]
    v_pk_fma_f32 v[132:133], v[196:197], v[222:223], v[132:133] op_sel_hi:[1,0,1]
    v_pk_fma_f32 v[148:149], v[196:197], v[222:223], v[148:149] op_sel:[0,1,0] op_sel_hi:[1,1,1]
    v_pk_fma_f32 v[134:135], v[198:199], v[222:223], v[134:135] op_sel_hi:[1,0,1]
    v_pk_fma_f32 v[150:151], v[198:199], v[222:223], v[150:151] op_sel:[0,1,0] op_sel_hi:[1,1,1]
    s_add_u32 s20, s20, 2883584
    s_mov_b32 exec_hi, 0
    buffer_atomic_add_f32 a32, v249, s[56:59], s20 offen offset:0
    buffer_atomic_add_f32 a48, v249, s[56:59], s20 offen offset:128
    buffer_atomic_add_f32 a64, v249, s[56:59], s20 offen offset:256
    buffer_atomic_add_f32 a80, v249, s[56:59], s20 offen offset:384
    s_mov_b64 exec, -1
    s_waitcnt lgkmcnt(8)
    v_pk_fma_f32 v[120:121], v[120:121], v[168:169], s[86:87] op_sel_hi:[1,1,0]
    v_pk_mul_f32 v[136:137], v[136:137], v[168:169]
    v_pk_fma_f32 v[122:123], v[122:123], v[170:171], s[86:87] op_sel_hi:[1,1,0]
    v_pk_mul_f32 v[138:139], v[138:139], v[170:171]
    v_pk_fma_f32 v[124:125], v[124:125], v[172:173], s[86:87] op_sel_hi:[1,1,0]
    v_pk_mul_f32 v[140:141], v[140:141], v[172:173]
    v_pk_fma_f32 v[126:127], v[126:127], v[174:175], s[86:87] op_sel_hi:[1,1,0]
    v_pk_mul_f32 v[142:143], v[142:143], v[174:175]
    v_pk_fma_f32 v[128:129], v[128:129], v[176:177], s[86:87] op_sel_hi:[1,1,0]
    v_pk_mul_f32 v[144:145], v[144:145], v[176:177]
    v_pk_fma_f32 v[130:131], v[130:131], v[178:179], s[86:87] op_sel_hi:[1,1,0]
    v_pk_mul_f32 v[146:147], v[146:147], v[178:179]
    v_pk_fma_f32 v[132:133], v[132:133], v[180:181], s[86:87] op_sel_hi:[1,1,0]
    v_pk_mul_f32 v[148:149], v[148:149], v[180:181]
    v_pk_fma_f32 v[134:135], v[134:135], v[182:183], s[86:87] op_sel_hi:[1,1,0]
    v_pk_mul_f32 v[150:151], v[150:151], v[182:183]
    s_waitcnt vmcnt(8)
    s_sub_u32 s80, s9, 51200
    v_add_u32 v215, s80, v213
    ds_read_b64_tr_b16 v[168:169], v215 offset:0
    ds_read_b64_tr_b16 v[170:171], v215 offset:256
    ds_read_b64_tr_b16 v[172:173], v215 offset:4096
    ds_read_b64_tr_b16 v[174:175], v215 offset:4352
    ds_read_b64_tr_b16 v[176:177], v215 offset:8192
    ds_read_b64_tr_b16 v[178:179], v215 offset:8448
    ds_read_b64_tr_b16 v[180:181], v215 offset:12288
    ds_read_b64_tr_b16 v[182:183], v215 offset:12544
    ds_read_b64_tr_b16 v[184:185], v215 offset:16384
    ds_read_b64_tr_b16 v[186:187], v215 offset:16640
    ds_read_b64_tr_b16 v[188:189], v215 offset:20480
    ds_read_b64_tr_b16 v[190:191], v215 offset:20736
    ds_read_b64_tr_b16 v[192:193], v215 offset:24576
    ds_read_b64_tr_b16 v[194:195], v215 offset:24832
    v_pk_mul_f32 v[152:153], v[120:121], s[86:87] op_sel:[0,1] op_sel_hi:[1,1]
    v_pk_mul_f32 v[154:155], v[122:123], s[86:87] op_sel:[0,1] op_sel_hi:[1,1]
    v_pk_mul_f32 v[156:157], v[124:125], s[86:87] op_sel:[0,1] op_sel_hi:[1,1]
    v_pk_mul_f32 v[158:159], v[126:127], s[86:87] op_sel:[0,1] op_sel_hi:[1,1]
    v_pk_mul_f32 v[160:161], v[128:129], s[86:87] op_sel:[0,1] op_sel_hi:[1,1]
    v_pk_mul_f32 v[162:163], v[130:131], s[86:87] op_sel:[0,1] op_sel_hi:[1,1]
    v_pk_mul_f32 v[164:165], v[132:133], s[86:87] op_sel:[0,1] op_sel_hi:[1,1]
    v_pk_mul_f32 v[166:167], v[134:135], s[86:87] op_sel:[0,1] op_sel_hi:[1,1]
    v_min_f32 v152, 0, v152
    v_min_f32 v153, 0, v153
    v_min_f32 v154, 0, v154
    v_min_f32 v155, 0, v155
    v_min_f32 v156, 0, v156
    v_min_f32 v157, 0, v157
    v_min_f32 v158, 0, v158
    v_min_f32 v159, 0, v159
    v_min_f32 v160, 0, v160
    v_min_f32 v161, 0, v161
    v_min_f32 v162, 0, v162
    v_min_f32 v163, 0, v163
    v_min_f32 v164, 0, v164
    v_min_f32 v165, 0, v165
    v_min_f32 v166, 0, v166
    v_min_f32 v167, 0, v167
    v_exp_f32 v152, v152
    v_max_f32 v120, s86, v120
    v_exp_f32 v153, v153
    v_max_f32 v121, s86, v121
    v_exp_f32 v154, v154
    v_max_f32 v122, s86, v122
    v_exp_f32 v155, v155
    v_max_f32 v123, s86, v123
    v_exp_f32 v156, v156
    v_max_f32 v124, s86, v124
    v_exp_f32 v157, v157
    v_max_f32 v125, s86, v125
    v_exp_f32 v158, v158
    v_max_f32 v126, s86, v126
    v_exp_f32 v159, v159
    v_max_f32 v127, s86, v127
    v_exp_f32 v160, v160
    v_max_f32 v128, s86, v128
    v_exp_f32 v161, v161
    v_max_f32 v129, s86, v129
    v_exp_f32 v162, v162
    v_max_f32 v130, s86, v130
    v_exp_f32 v163, v163
    v_max_f32 v131, s86, v131
    v_exp_f32 v164, v164
    v_max_f32 v132, s86, v132
    v_exp_f32 v165, v165
    v_max_f32 v133, s86, v133
    v_exp_f32 v166, v166
    v_max_f32 v134, s86, v134
    v_exp_f32 v167, v167
    v_max_f32 v135, s86, v135
    v_pk_add_f32 v[120:121], v[120:121], v[152:153]
    v_pk_add_f32 v[122:123], v[122:123], v[154:155]
    v_pk_add_f32 v[124:125], v[124:125], v[156:157]
    v_pk_add_f32 v[126:127], v[126:127], v[158:159]
    v_pk_add_f32 v[128:129], v[128:129], v[160:161]
    v_pk_add_f32 v[130:131], v[130:131], v[162:163]
    v_pk_add_f32 v[132:133], v[132:133], v[164:165]
    v_pk_add_f32 v[134:135], v[134:135], v[166:167]
    v_cvt_pk_bf16_f32 v120, v120, v121
    v_cvt_pk_bf16_f32 v136, v136, v137
    v_cvt_pk_bf16_f32 v121, v122, v123
    v_cvt_pk_bf16_f32 v137, v138, v139
    v_cvt_pk_bf16_f32 v122, v124, v125
    v_cvt_pk_bf16_f32 v138, v140, v141
    v_cvt_pk_bf16_f32 v123, v126, v127
    v_cvt_pk_bf16_f32 v139, v142, v143
    v_cvt_pk_bf16_f32 v124, v128, v129
    v_cvt_pk_bf16_f32 v140, v144, v145
    v_cvt_pk_bf16_f32 v125, v130, v131
    v_cvt_pk_bf16_f32 v141, v146, v147
    v_cvt_pk_bf16_f32 v126, v132, v133
    v_cvt_pk_bf16_f32 v142, v148, v149
    v_cvt_pk_bf16_f32 v127, v134, v135
    v_cvt_pk_bf16_f32 v143, v150, v151
    s_mov_b64 exec, s[88:89]
    v_mov_b32 v136, s85
    v_mov_b32 v137, s85
    v_mov_b32 v138, s85
    v_mov_b32 v139, s85
    v_mov_b32 v140, s85
    v_mov_b32 v141, s85
    v_mov_b32 v142, s85
    v_mov_b32 v143, s85
    s_mov_b64 exec, -1
    v_mfma_f32_32x32x16_bf16 a[240:255], v[120:123], v[136:139], 0
    v_mfma_f32_32x32x16_bf16 a[240:255], v[124:127], v[140:143], a[240:255]
    s_waitcnt lgkmcnt(0)
    v_mfma_f32_32x32x16_bf16 a[224:239], v[200:203], v[168:171], 0
    v_mfma_f32_32x32x16_bf16 a[224:239], v[200:203], v[172:175], a[224:239]
    s_nop 8
    ds_write_b128 v206, a[240:243] offset:0
    ds_write_b128 v206, a[244:247] offset:32
    ds_write_b128 v206, a[248:251] offset:64
    ds_write_b128 v206, a[252:255] offset:96
    v_mfma_f32_32x32x16_bf16 a[224:239], v[200:203], v[176:179], a[224:239]
    v_mfma_f32_32x32x16_bf16 a[224:239], v[200:203], v[180:183], a[224:239]
    v_mfma_f32_32x32x16_bf16 a[224:239], v[200:203], v[184:187], a[224:239]
    v_mfma_f32_32x32x16_bf16 a[224:239], v[200:203], v[188:191], a[224:239]
    v_mfma_f32_32x32x16_bf16 a[224:239], v[200:203], v[192:195], a[224:239]
    s_mov_b32 s8, s71
    s_lshl_b32 s82, s70, 12
    s_add_u32 s82, s82, s9
    s_add_u32 s82, s82, 2097152
    s_nop 7
    ds_write_b32 v225, a224 offset:1024
    s_waitcnt vmcnt(0) lgkmcnt(0)
    s_barrier
    ds_read_b32 v184, v204 offset:0
    ds_read_b32 v185, v204 offset:4608
    ds_read_b32 v186, v204 offset:9216
    ds_read_b32 v187, v204 offset:13824
    ds_read_b32 v188, v205 offset:0
    ds_read_b32 v189, v205 offset:4608
    ds_read_b32 v190, v205 offset:9216
    ds_read_b32 v191, v205 offset:13824
    ds_read_b32 v192, v204 offset:16
    ds_read_b32 v193, v204 offset:4624
    ds_read_b32 v194, v204 offset:9232
    ds_read_b32 v195, v204 offset:13840
    ds_read_b32 v196, v205 offset:16
    ds_read_b32 v197, v205 offset:4624
    ds_read_b32 v198, v205 offset:9232
    ds_read_b32 v199, v205 offset:13840
    s_waitcnt lgkmcnt(12)
    v_add_f32 v184, v184, v185
    v_add_f32 v186, v186, v187
    v_add_f32 v184, v184, v186
    buffer_atomic_add_f32 v184, v249, s[56:59], s82 offen offset:0
    s_waitcnt lgkmcnt(8)
    v_add_f32 v188, v188, v189
    v_add_f32 v190, v190, v191
    v_add_f32 v188, v188, v190
    buffer_atomic_add_f32 v188, v249, s[56:59], s82 offen offset:256
    s_waitcnt lgkmcnt(4)
    v_add_f32 v192, v192, v193
    v_add_f32 v194, v194, v195
    v_add_f32 v192, v192, v194
    s_waitcnt lgkmcnt(0)
    v_add_f32 v196, v196, v197
    v_add_f32 v198, v198, v199
    v_add_f32 v196, v196, v198
    s_cmp_eq_u32 s68, 3
    s_nop 1
    s_cbranch_scc1 kf_noat
    buffer_atomic_add_f32 v192, v249, s[56:59], s82 offen offset:512
    buffer_atomic_add_f32 v196, v249, s[56:59], s82 offen offset:768
kf_noat:
    v_mov_b32 v2, 1
    v_mov_b32 v3, 0
    s_mov_b64 exec, 1
    buffer_atomic_add v2, v3, s[60:63], s19 offen sc1
    s_mov_b64 exec, -1
    s_lshl_b32 s80, s8, 12
    s_sub_u32 s80, s80, 51200
    v_add_u32 v214, s80, v213
    s_add_u32 s8, s8, 1
    s_cmp_eq_u32 s8, 7
    s_cselect_b32 s8, 0, s8
    ds_read_b64_tr_b16 v[168:169], v214 offset:0
    ds_read_b64_tr_b16 v[170:171], v214 offset:256
    ds_read_b64_tr_b16 v[172:173], v214 offset:1024
    ds_read_b64_tr_b16 v[174:175], v214 offset:1280
    ds_read_b64_tr_b16 v[176:177], v214 offset:2048
    ds_read_b64_tr_b16 v[178:179], v214 offset:2304
    ds_read_b64_tr_b16 v[180:181], v214 offset:3072
    ds_read_b64_tr_b16 v[182:183], v214 offset:3328
    s_waitcnt lgkmcnt(6)
    v_mfma_f32_32x32x16_bf16 v[152:167], v[168:171], v[8:11], 0
    v_add_u32 v2, 30720, v224
    ds_read_b32 v128, v2 offset:0
    s_lshl_b32 s80, s8, 12
    s_sub_u32 s80, s80, 51200
    v_add_u32 v214, s80, v213
    s_add_u32 s8, s8, 1
    s_cmp_eq_u32 s8, 7
    s_cselect_b32 s8, 0, s8
    ds_read_b64_tr_b16 v[168:169], v214 offset:0
    ds_read_b64_tr_b16 v[170:171], v214 offset:256
    s_waitcnt lgkmcnt(7)
    v_mfma_f32_32x32x16_bf16 v[152:167], v[172:175], v[12:15], v[152:167]
    ds_read_b32 v129, v2 offset:128
    ds_read_b32 v130, v2 offset:256
    ds_read_b32 v131, v2 offset:384
    ds_read_b64_tr_b16 v[172:173], v214 offset:1024
    ds_read_b64_tr_b16 v[174:175], v214 offset:1280
    s_waitcnt lgkmcnt(10)
    v_mfma_f32_32x32x16_bf16 v[152:167], v[176:179], v[16:19], v[152:167]
    s_lshl_b32 s79, s68, 7
    s_add_u32 s79, s79, 31232
    v_add_u32 v3, s79, v224
    ds_read_b64_tr_b16 v[176:177], v214 offset:2048
    ds_read_b64_tr_b16 v[178:179], v214 offset:2304
    s_waitcnt lgkmcnt(10)
    v_mfma_f32_32x32x16_bf16 v[152:167], v[180:183], v[20:23], v[152:167]
    v_lshrrev_b32 v4, 5, v1
    v_lshlrev_b32 v4, 4, v4
    v_add_u32 v4, s79, v4
    s_waitcnt lgkmcnt(4)
    ds_read_b64_tr_b16 v[180:181], v214 offset:3072
    ds_read_b64_tr_b16 v[182:183], v214 offset:3328
    s_waitcnt lgkmcnt(9)
    v_mfma_f32_32x32x16_bf16 v[152:167], v[168:171], v[24:27], v[152:167]
    v_add_f32 v128, v128, v129
    v_add_f32 v130, v130, v131
    s_lshl_b32 s80, s8, 12
    s_sub_u32 s80, s80, 51200
    v_add_u32 v214, s80, v213
    s_add_u32 s8, s8, 1
    s_cmp_eq_u32 s8, 7
    s_cselect_b32 s8, 0, s8
    ds_read_b64_tr_b16 v[168:169], v214 offset:0
    ds_read_b64_tr_b16 v[170:171], v214 offset:256
    s_waitcnt lgkmcnt(6)
    v_mfma_f32_32x32x16_bf16 v[152:167], v[172:175], v[28:31], v[152:167]
    v_add_f32 v128, v128, v130
    ds_write_b32 v3, v128
    ds_read_b128 v[136:139], v4 offset:0
    ds_read_b64_tr_b16 v[172:173], v214 offset:1024
    ds_read_b64_tr_b16 v[174:175], v214 offset:1280
    s_waitcnt lgkmcnt(8)
    v_mfma_f32_32x32x16_bf16 v[152:167], v[176:179], v[32:35], v[152:167]
    ds_read_b128 v[140:143], v4 offset:32
    ds_read_b128 v[144:147], v4 offset:64
    ds_read_b64_tr_b16 v[176:177], v214 offset:2048
    ds_read_b64_tr_b16 v[178:179], v214 offset:2304
    s_waitcnt lgkmcnt(10)
    v_mfma_f32_32x32x16_bf16 v[152:167], v[180:183], v[36:39], v[152:167]
    ds_read_b128 v[148:151], v4 offset:96
    ds_read_b64_tr_b16 v[180:181], v214 offset:3072
    ds_read_b64_tr_b16 v[182:183], v214 offset:3328
    s_waitcnt lgkmcnt(11)
    v_mfma_f32_32x32x16_bf16 v[152:167], v[168:171], v[40:43], v[152:167]
    s_lshl_b32 s80, s8, 12
    s_sub_u32 s80, s80, 51200
    v_add_u32 v214, s80, v213
    s_add_u32 s8, s8, 1
    s_cmp_eq_u32 s8, 7
    s_cselect_b32 s8, 0, s8
    ds_read_b64_tr_b16 v[168:169], v214 offset:0
    ds_read_b64_tr_b16 v[170:171], v214 offset:256
    s_waitcnt lgkmcnt(9)
    v_mfma_f32_32x32x16_bf16 v[152:167], v[172:175], v[44:47], v[152:167]
    ds_read_b64_tr_b16 v[172:173], v214 offset:1024
    ds_read_b64_tr_b16 v[174:175], v214 offset:1280
    s_waitcnt lgkmcnt(7)
    v_mfma_f32_32x32x16_bf16 v[152:167], v[176:179], v[48:51], v[152:167]
    ds_read_b64_tr_b16 v[176:177], v214 offset:2048
    ds_read_b64_tr_b16 v[178:179], v214 offset:2304
    s_waitcnt lgkmcnt(6)
    v_mfma_f32_32x32x16_bf16 v[152:167], v[180:183], v[52:55], v[152:167]
    ds_read_b64_tr_b16 v[180:181], v214 offset:3072
    ds_read_b64_tr_b16 v[182:183], v214 offset:3328
    s_waitcnt lgkmcnt(6)
    v_mfma_f32_32x32x16_bf16 v[152:167], v[168:171], v[56:59], v[152:167]
    s_lshl_b32 s80, s8, 12
    s_sub_u32 s80, s80, 51200
    v_add_u32 v214, s80, v213
    s_add_u32 s8, s8, 1
    s_cmp_eq_u32 s8, 7
    s_cselect_b32 s8, 0, s8
    ds_read_b64_tr_b16 v[168:169], v214 offset:0
    ds_read_b64_tr_b16 v[170:171], v214 offset:256
    s_waitcnt lgkmcnt(6)
    v_mfma_f32_32x32x16_bf16 v[152:167], v[172:175], v[60:63], v[152:167]
    ds_read_b64_tr_b16 v[172:173], v214 offset:1024
    ds_read_b64_tr_b16 v[174:175], v214 offset:1280
    s_waitcnt lgkmcnt(6)
    v_mfma_f32_32x32x16_bf16 v[152:167], v[176:179], v[64:67], v[152:167]
    ds_read_b64_tr_b16 v[176:177], v214 offset:2048
    ds_read_b64_tr_b16 v[178:179], v214 offset:2304
    s_waitcnt lgkmcnt(6)
    v_mfma_f32_32x32x16_bf16 v[152:167], v[180:183], v[68:71], v[152:167]
    ds_read_b64_tr_b16 v[180:181], v214 offset:3072
    ds_read_b64_tr_b16 v[182:183], v214 offset:3328
    s_waitcnt lgkmcnt(6)
    v_mfma_f32_32x32x16_bf16 v[152:167], v[168:171], v[72:75], v[152:167]
    s_lshl_b32 s80, s8, 12
    s_sub_u32 s80, s80, 51200
    v_add_u32 v214, s80, v213
    s_add_u32 s8, s8, 1
    s_cmp_eq_u32 s8, 7
    s_cselect_b32 s8, 0, s8
    ds_read_b64_tr_b16 v[168:169], v214 offset:0
    ds_read_b64_tr_b16 v[170:171], v214 offset:256
    s_waitcnt lgkmcnt(6)
    v_mfma_f32_32x32x16_bf16 v[152:167], v[172:175], v[76:79], v[152:167]
    ds_read_b64_tr_b16 v[172:173], v214 offset:1024
    ds_read_b64_tr_b16 v[174:175], v214 offset:1280
    s_waitcnt lgkmcnt(6)
    v_mfma_f32_32x32x16_bf16 v[152:167], v[176:179], v[80:83], v[152:167]
    ds_read_b64_tr_b16 v[176:177], v214 offset:2048
    ds_read_b64_tr_b16 v[178:179], v214 offset:2304
    s_waitcnt lgkmcnt(6)
    v_mfma_f32_32x32x16_bf16 v[152:167], v[180:183], v[84:87], v[152:167]
    ds_read_b64_tr_b16 v[180:181], v214 offset:3072
    ds_read_b64_tr_b16 v[182:183], v214 offset:3328
    s_waitcnt lgkmcnt(6)
    v_mfma_f32_32x32x16_bf16 v[152:167], v[168:171], v[88:91], v[152:167]
    s_lshl_b32 s80, s8, 12
    s_sub_u32 s80, s80, 51200
    v_add_u32 v214, s80, v213
    s_add_u32 s8, s8, 1
    s_cmp_eq_u32 s8, 7
    s_cselect_b32 s8, 0, s8
    ds_read_b64_tr_b16 v[168:169], v214 offset:0
    ds_read_b64_tr_b16 v[170:171], v214 offset:256
    s_waitcnt lgkmcnt(6)
    v_mfma_f32_32x32x16_bf16 v[152:167], v[172:175], v[92:95], v[152:167]
    ds_read_b64_tr_b16 v[172:173], v214 offset:1024
    ds_read_b64_tr_b16 v[174:175], v214 offset:1280
    s_waitcnt lgkmcnt(6)
    v_mfma_f32_32x32x16_bf16 v[152:167], v[176:179], v[96:99], v[152:167]
    ds_read_b64_tr_b16 v[176:177], v214 offset:2048
    ds_read_b64_tr_b16 v[178:179], v214 offset:2304
    s_waitcnt lgkmcnt(6)
    v_mfma_f32_32x32x16_bf16 v[152:167], v[180:183], v[100:103], v[152:167]
    ds_read_b64_tr_b16 v[180:181], v214 offset:3072
    ds_read_b64_tr_b16 v[182:183], v214 offset:3328
    s_waitcnt lgkmcnt(6)
    v_mfma_f32_32x32x16_bf16 v[152:167], v[168:171], v[104:107], v[152:167]
    s_waitcnt lgkmcnt(4)
    v_mfma_f32_32x32x16_bf16 v[152:167], v[172:175], v[108:111], v[152:167]
    s_waitcnt lgkmcnt(2)
    v_mfma_f32_32x32x16_bf16 v[152:167], v[176:179], v[112:115], v[152:167]
    s_waitcnt lgkmcnt(0)
    v_mfma_f32_32x32x16_bf16 v[152:167], v[180:183], v[116:119], v[152:167]
    s_waitcnt lgkmcnt(15)
    s_nop 10
    v_pk_fma_f32 v[152:153], v[136:137], v[220:221], v[152:153] op_sel:[0,1,0] op_sel_hi:[1,1,1]
    v_pk_fma_f32 v[154:155], v[138:139], v[220:221], v[154:155] op_sel:[0,1,0] op_sel_hi:[1,1,1]
    v_pk_fma_f32 v[156:157], v[140:141], v[220:221], v[156:157] op_sel:[0,1,0] op_sel_hi:[1,1,1]
    v_pk_fma_f32 v[158:159], v[142:143], v[220:221], v[158:159] op_sel:[0,1,0] op_sel_hi:[1,1,1]
    v_pk_fma_f32 v[160:161], v[144:145], v[220:221], v[160:161] op_sel:[0,1,0] op_sel_hi:[1,1,1]
    v_pk_fma_f32 v[162:163], v[146:147], v[220:221], v[162:163] op_sel:[0,1,0] op_sel_hi:[1,1,1]
    v_pk_fma_f32 v[164:165], v[148:149], v[220:221], v[164:165] op_sel:[0,1,0] op_sel_hi:[1,1,1]
    v_pk_fma_f32 v[166:167], v[150:151], v[220:221], v[166:167] op_sel:[0,1,0] op_sel_hi:[1,1,1]
    v_pk_fma_f32 v[152:153], v[152:153], v[220:221], s[86:87] op_sel_hi:[1,0,0]
    v_pk_fma_f32 v[154:155], v[154:155], v[220:221], s[86:87] op_sel_hi:[1,0,0]
    v_pk_fma_f32 v[156:157], v[156:157], v[220:221], s[86:87] op_sel_hi:[1,0,0]
    v_pk_fma_f32 v[158:159], v[158:159], v[220:221], s[86:87] op_sel_hi:[1,0,0]
    v_pk_fma_f32 v[160:161], v[160:161], v[220:221], s[86:87] op_sel_hi:[1,0,0]
    v_pk_fma_f32 v[162:163], v[162:163], v[220:221], s[86:87] op_sel_hi:[1,0,0]
    v_pk_fma_f32 v[164:165], v[164:165], v[220:221], s[86:87] op_sel_hi:[1,0,0]
    v_pk_fma_f32 v[166:167], v[166:167], v[220:221], s[86:87] op_sel_hi:[1,0,0]
    v_pk_mul_f32 v[168:169], v[152:153], s[86:87] op_sel:[0,1] op_sel_hi:[1,1]
    v_pk_mul_f32 v[170:171], v[154:155], s[86:87] op_sel:[0,1] op_sel_hi:[1,1]
    v_pk_mul_f32 v[172:173], v[156:157], s[86:87] op_sel:[0,1] op_sel_hi:[1,1]
    v_pk_mul_f32 v[174:175], v[158:159], s[86:87] op_sel:[0,1] op_sel_hi:[1,1]
    v_pk_mul_f32 v[176:177], v[160:161], s[86:87] op_sel:[0,1] op_sel_hi:[1,1]
    v_pk_mul_f32 v[178:179], v[162:163], s[86:87] op_sel:[0,1] op_sel_hi:[1,1]
    v_pk_mul_f32 v[180:181], v[164:165], s[86:87] op_sel:[0,1] op_sel_hi:[1,1]
    v_pk_mul_f32 v[182:183], v[166:167], s[86:87] op_sel:[0,1] op_sel_hi:[1,1]
    v_min_f32 v168, 0, v168
    v_min_f32 v169, 0, v169
    v_min_f32 v170, 0, v170
    v_min_f32 v171, 0, v171
    v_min_f32 v172, 0, v172
    v_min_f32 v173, 0, v173
    v_min_f32 v174, 0, v174
    v_min_f32 v175, 0, v175
    v_min_f32 v176, 0, v176
    v_min_f32 v177, 0, v177
    v_min_f32 v178, 0, v178
    v_min_f32 v179, 0, v179
    v_min_f32 v180, 0, v180
    v_min_f32 v181, 0, v181
    v_min_f32 v182, 0, v182
    v_min_f32 v183, 0, v183
    v_exp_f32 v168, v168
    v_max_f32 v152, s86, v152
    v_exp_f32 v169, v169
    v_max_f32 v153, s86, v153
    v_exp_f32 v170, v170
    v_max_f32 v154, s86, v154
    v_exp_f32 v171, v171
    v_max_f32 v155, s86, v155
    v_exp_f32 v172, v172
    v_max_f32 v156, s86, v156
    v_exp_f32 v173, v173
    v_max_f32 v157, s86, v157
    v_exp_f32 v174, v174
    v_max_f32 v158, s86, v158
    v_exp_f32 v175, v175
    v_max_f32 v159, s86, v159
    v_exp_f32 v176, v176
    v_max_f32 v160, s86, v160
    v_exp_f32 v177, v177
    v_max_f32 v161, s86, v161
    v_exp_f32 v178, v178
    v_max_f32 v162, s86, v162
    v_exp_f32 v179, v179
    v_max_f32 v163, s86, v163
    v_exp_f32 v180, v180
    v_max_f32 v164, s86, v164
    v_exp_f32 v181, v181
    v_max_f32 v165, s86, v165
    v_exp_f32 v182, v182
    v_max_f32 v166, s86, v166
    v_exp_f32 v183, v183
    v_max_f32 v167, s86, v167
    v_pk_add_f32 v[152:153], v[152:153], v[168:169]
    v_pk_add_f32 v[154:155], v[154:155], v[170:171]
    v_pk_add_f32 v[156:157], v[156:157], v[172:173]
    v_pk_add_f32 v[158:159], v[158:159], v[174:175]
    v_pk_add_f32 v[160:161], v[160:161], v[176:177]
    v_pk_add_f32 v[162:163], v[162:163], v[178:179]
    v_pk_add_f32 v[164:165], v[164:165], v[180:181]
    v_pk_add_f32 v[166:167], v[166:167], v[182:183]
    v_cvt_pk_bf16_f32 v120, v152, v153
    v_cvt_pk_bf16_f32 v121, v154, v155
    v_cvt_pk_bf16_f32 v122, v156, v157
    v_cvt_pk_bf16_f32 v123, v158, v159
    v_cvt_pk_bf16_f32 v124, v160, v161
    v_cvt_pk_bf16_f32 v125, v162, v163
    v_cvt_pk_bf16_f32 v126, v164, v165
    v_cvt_pk_bf16_f32 v127, v166, v167
    v_cndmask_b32 v126, 0, v126, s[90:91]
    v_cndmask_b32 v127, 0, v127, s[90:91]
    s_lshl_b32 s77, s69, 2
    s_add_u32 s77, s77, s68
    s_lshl_b32 s78, s70, 6
    s_add_u32 s77, s77, s78
    s_lshl_b32 s77, s77, 11
    buffer_store_dwordx4 v[120:123], v240, s[56:59], s77 offen sc1
    buffer_store_dwordx4 v[124:127], v240, s[56:59], s77 offen offset:1024 sc1
    s_lshl_b32 s81, s75, 8
    s_add_u32 s81, s81, 2240512
    s_lshl_b32 s82, s73, 8
    s_add_u32 s82, s82, 2244608
    v_mov_b32 v227, s82
    v_writelane_b32 v227, s81, 0
    v_mov_b32 v250, 4
    v_writelane_b32 v250, 14, 0
    buffer_load_dword v248, v227, s[56:59], 0 offen sc1
    s_lshr_b32 s83, s70, 2
    s_lshl_b32 s83, s83, 7
    s_add_u32 s83, s83, 2228224
    v_mov_b32 v2, 1
    v_lshlrev_b32 v3, 9, v1
    s_waitcnt vmcnt(1)
    s_barrier
    s_mov_b64 exec, 0xff
    buffer_atomic_add v2, v3, s[60:63], s83 offen sc1
    s_mov_b64 exec, -1
    s_and_b32 s77, s2, 0xc2
    s_cmp_eq_u32 s77, 0xc2
    s_cbranch_scc1 kf_pack
    s_mov_b32 s94, 0
    s_waitcnt vmcnt(1)
    s_branch kf_pg_chk
kf_pg:
    buffer_load_dword v248, v227, s[56:59], 0 offen sc1
    s_add_u32 s94, s94, 1
    s_waitcnt vmcnt(0)
kf_pg_chk:
    v_cmp_le_u32 vcc, v250, v248
    s_cmp_ge_u32 s94, 524288
    s_nop 3
    s_cbranch_scc1 kf_pg_ok
    s_and_b32 s84, vcc_lo, 3
    s_cmp_eq_u32 s84, 3
    s_cbranch_scc1 kf_pg_ok
    s_sleep 1
    s_branch kf_pg
kf_pg_ok:
    s_add_u32 s79, s76, 0
    s_and_b32 s79, s79, 3
    s_lshl_b32 s80, s68, 2
    s_add_u32 s79, s79, s80
    s_lshl_b32 s79, s79, 11
    s_lshl_b32 s80, s73, 1
    s_and_b32 s81, s68, 1
    s_add_u32 s80, s80, s81
    s_lshl_b32 s80, s80, 15
    s_add_u32 s79, s79, s80
    s_xor_b32 s80, s79, 32768
    s_add_u32 s79, s79, 2359296
    s_add_u32 s80, s80, 2359296
    buffer_load_dwordx4 v[8:11], v240, s[56:59], s79 offen offset:0 sc1
    buffer_load_dwordx4 v[12:15], v240, s[56:59], s79 offen offset:1024 sc1
    buffer_load_dwordx4 v[16:19], v240, s[56:59], s80 offen offset:0 sc1
    buffer_load_dwordx4 v[20:23], v240, s[56:59], s80 offen offset:1024 sc1
    s_add_u32 s79, s76, 1
    s_and_b32 s79, s79, 3
    s_lshl_b32 s80, s68, 2
    s_add_u32 s79, s79, s80
    s_lshl_b32 s79, s79, 11
    s_lshl_b32 s80, s73, 1
    s_and_b32 s81, s68, 1
    s_add_u32 s80, s80, s81
    s_lshl_b32 s80, s80, 15
    s_add_u32 s79, s79, s80
    s_xor_b32 s80, s79, 32768
    s_add_u32 s79, s79, 2359296
    s_add_u32 s80, s80, 2359296
    buffer_load_dwordx4 v[24:27], v240, s[56:59], s79 offen offset:0 sc1
    buffer_load_dwordx4 v[28:31], v240, s[56:59], s79 offen offset:1024 sc1
    buffer_load_dwordx4 v[32:35], v240, s[56:59], s80 offen offset:0 sc1
    buffer_load_dwordx4 v[36:39], v240, s[56:59], s80 offen offset:1024 sc1
    s_add_u32 s79, s76, 2
    s_and_b32 s79, s79, 3
    s_lshl_b32 s80, s68, 2
    s_add_u32 s79, s79, s80
    s_lshl_b32 s79, s79, 11
    s_lshl_b32 s80, s73, 1
    s_and_b32 s81, s68, 1
    s_add_u32 s80, s80, s81
    s_lshl_b32 s80, s80, 15
    s_add_u32 s79, s79, s80
    s_xor_b32 s80, s79, 32768
    s_add_u32 s79, s79, 2359296
    s_add_u32 s80, s80, 2359296
    buffer_load_dwordx4 v[40:43], v240, s[56:59], s79 offen offset:0 sc1
    buffer_load_dwordx4 v[44:47], v240, s[56:59], s79 offen offset:1024 sc1
    buffer_load_dwordx4 v[48:51], v240, s[56:59], s80 offen offset:0 sc1
    buffer_load_dwordx4 v[52:55], v240, s[56:59], s80 offen offset:1024 sc1
    s_add_u32 s79, s76, 3
    s_and_b32 s79, s79, 3
    s_lshl_b32 s80, s68, 2
    s_add_u32 s79, s79, s80
    s_lshl_b32 s79, s79, 11
    s_lshl_b32 s80, s73, 1
    s_and_b32 s81, s68, 1
    s_add_u32 s80, s80, s81
    s_lshl_b32 s80, s80, 15
    s_add_u32 s79, s79, s80
    s_xor_b32 s80, s79, 32768
    s_add_u32 s79, s79, 2359296
    s_add_u32 s80, s80, 2359296
    buffer_load_dwordx4 v[56:59], v240, s[56:59], s79 offen offset:0 sc1
    buffer_load_dwordx4 v[60:63], v240, s[56:59], s79 offen offset:1024 sc1
    buffer_load_dwordx4 v[64:67], v240, s[56:59], s80 offen offset:0 sc1
    buffer_load_dwordx4 v[68:71], v240, s[56:59], s80 offen offset:1024 sc1
    s_lshr_b32 s77, s68, 1
    s_and_b32 s78, s68, 1
    s_lshl_b32 s4, s72, 1
    s_add_u32 s4, s4, s77
    s_lshl_b32 s5, s73, 1
    s_add_u32 s5, s5, s78
    s_mul_i32 s79, s4, 28672
    s_lshl_b32 s80, s5, 6
    s_add_u32 s79, s79, s80
    buffer_load_dwordx4 v[232:235], v251, s[24:27], s79 offen offset:0
    buffer_load_dwordx4 v[236:239], v251, s[24:27], s79 offen offset:32
    s_and_b32 s79, s2, 7
    s_lshl_b32 s79, s79, 2
    s_add_u32 s79, s79, s68
    s_lshl_b32 s79, s79, 7
    s_add_u32 s79, s79, 2228224
    v_mov_b32 v249, s79
    s_lshl_b32 s6, s68, 14
    s_add_u32 s6, s6, 2097152
    s_lshl_b32 s7, s68, 19
    s_lshl_b32 s79, s72, 12
    s_add_u32 s7, s7, s79
    s_lshl_b32 s8, s77, 11
    s_mov_b32 s94, 0
kf_p1:
    buffer_load_dword v248, v249, s[56:59], 0 offen sc1
    s_add_u32 s94, s94, 1
    s_waitcnt vmcnt(0)
kf_p1_chk:
    v_cmp_le_u32 vcc, 64, v248
    s_cmp_ge_u32 s94, 524288
    s_nop 3
    s_cbranch_scc1 kf_p1_ok
    s_and_b32 s84, vcc_lo, 1
    s_cmp_eq_u32 s84, 1
    s_cbranch_scc1 kf_p1_ok
    s_sleep 1
    s_branch kf_p1
kf_p1_ok:
    s_add_u32 s79, s76, 0
    s_and_b32 s79, s79, 3
    s_lshl_b32 s80, s79, 12
    s_add_u32 s80, s80, s6
    s_lshl_b32 s81, s79, 17
    s_add_u32 s81, s81, s7
    s_add_u32 s82, s81, s8
    s_xor_b32 s81, s82, 2048
    buffer_load_dwordx4 v[136:139], v240, s[56:59], s80 offen offset:0 sc1
    buffer_load_dwordx4 v[140:143], v240, s[56:59], s80 offen offset:1024 sc1
    buffer_load_dwordx4 v[144:147], v240, s[56:59], s80 offen offset:2048 sc1
    buffer_load_dwordx4 v[148:151], v240, s[56:59], s80 offen offset:3072 sc1
    buffer_load_dwordx4 a[224:227], v240, s[56:59], s82 offen offset:0 sc1
    buffer_load_dwordx4 a[228:231], v240, s[56:59], s82 offen offset:1024 sc1
    buffer_load_dwordx4 a[232:235], v240, s[56:59], s81 offen offset:0 sc1
    buffer_load_dwordx4 a[236:239], v240, s[56:59], s81 offen offset:1024 sc1
    s_add_u32 s79, s76, 1
    s_and_b32 s79, s79, 3
    s_lshl_b32 s80, s79, 12
    s_add_u32 s80, s80, s6
    s_lshl_b32 s81, s79, 17
    s_add_u32 s81, s81, s7
    s_add_u32 s82, s81, s8
    s_xor_b32 s81, s82, 2048
    buffer_load_dwordx4 v[152:155], v240, s[56:59], s80 offen offset:0 sc1
    buffer_load_dwordx4 v[156:159], v240, s[56:59], s80 offen offset:1024 sc1
    buffer_load_dwordx4 v[160:163], v240, s[56:59], s80 offen offset:2048 sc1
    buffer_load_dwordx4 v[164:167], v240, s[56:59], s80 offen offset:3072 sc1
    buffer_load_dwordx4 a[240:243], v240, s[56:59], s82 offen offset:0 sc1
    buffer_load_dwordx4 a[244:247], v240, s[56:59], s82 offen offset:1024 sc1
    buffer_load_dwordx4 a[248:251], v240, s[56:59], s81 offen offset:0 sc1
    buffer_load_dwordx4 a[252:255], v240, s[56:59], s81 offen offset:1024 sc1
    v_mov_b32 v168, v232
    v_mov_b32 v169, v233
    v_mov_b32 v170, v234
    v_mov_b32 v171, v235
    v_mov_b32 v172, v236
    v_mov_b32 v173, v237
    v_mov_b32 v174, v238
    v_mov_b32 v175, v239
    v_permlane32_swap_b32 v168, v170
    v_permlane32_swap_b32 v169, v171
    v_permlane32_swap_b32 v172, v174
    v_permlane32_swap_b32 v173, v175
    v_lshlrev_b32 v72, 16, v168
    v_and_b32 v73, 0xffff0000, v168
    v_lshlrev_b32 v74, 16, v169
    v_and_b32 v75, 0xffff0000, v169
    v_lshlrev_b32 v76, 16, v170
    v_and_b32 v77, 0xffff0000, v170
    v_lshlrev_b32 v78, 16, v171
    v_and_b32 v79, 0xffff0000, v171
    v_lshlrev_b32 v80, 16, v172
    v_and_b32 v81, 0xffff0000, v172
    v_lshlrev_b32 v82, 16, v173
    v_and_b32 v83, 0xffff0000, v173
    v_lshlrev_b32 v84, 16, v174
    v_and_b32 v85, 0xffff0000, v174
    v_lshlrev_b32 v86, 16, v175
    v_and_b32 v87, 0xffff0000, v175
    s_waitcnt vmcnt(12)
    v_cvt_pk_bf16_f32 v136, v136, v137
    v_cvt_pk_bf16_f32 v137, v138, v139
    v_cvt_pk_bf16_f32 v138, v140, v141
    v_cvt_pk_bf16_f32 v139, v142, v143
    v_cvt_pk_bf16_f32 v140, v144, v145
    v_cvt_pk_bf16_f32 v141, v146, v147
    v_cvt_pk_bf16_f32 v142, v148, v149
    v_cvt_pk_bf16_f32 v143, v150, v151
    s_waitcnt vmcnt(8)
    v_mfma_f32_32x32x16_bf16 v[168:183], v[136:139], a[224:227], 0
    v_mfma_f32_32x32x16_bf16 v[168:183], v[140:143], a[228:231], v[168:183]
    v_mfma_f32_32x32x16_bf16 v[184:199], v[136:139], a[232:235], 0
    v_mfma_f32_32x32x16_bf16 v[184:199], v[140:143], a[236:239], v[184:199]
    s_add_u32 s79, s76, 2
    s_and_b32 s79, s79, 3
    s_lshl_b32 s80, s79, 12
    s_add_u32 s80, s80, s6
    s_lshl_b32 s81, s79, 17
    s_add_u32 s81, s81, s7
    s_add_u32 s82, s81, s8
    s_xor_b32 s81, s82, 2048
    buffer_load_dwordx4 v[136:139], v240, s[56:59], s80 offen offset:0 sc1
    buffer_load_dwordx4 v[140:143], v240, s[56:59], s80 offen offset:1024 sc1
    buffer_load_dwordx4 v[144:147], v240, s[56:59], s80 offen offset:2048 sc1
    buffer_load_dwordx4 v[148:151], v240, s[56:59], s80 offen offset:3072 sc1
    buffer_load_dwordx4 a[224:227], v240, s[56:59], s82 offen offset:0 sc1
    buffer_load_dwordx4 a[228:231], v240, s[56:59], s82 offen offset:1024 sc1
    buffer_load_dwordx4 a[232:235], v240, s[56:59], s81 offen offset:0 sc1
    buffer_load_dwordx4 a[236:239], v240, s[56:59], s81 offen offset:1024 sc1
    v_cvt_pk_bf16_f32 v2, v182, v182
    v_and_b32 v2, 0xffff0000, v2
    v_add_f32 v2, s86, v2
    v_rcp_f32 v2, v2
    s_nop 0
    v_mul_f32 v168, v168, v2
    v_mul_f32 v169, v169, v2
    v_mul_f32 v170, v170, v2
    v_mul_f32 v171, v171, v2
    v_mul_f32 v172, v172, v2
    v_mul_f32 v173, v173, v2
    v_mul_f32 v174, v174, v2
    v_mul_f32 v175, v175, v2
    v_mul_f32 v176, v176, v2
    v_mul_f32 v177, v177, v2
    v_mul_f32 v178, v178, v2
    v_mul_f32 v179, v179, v2
    v_mul_f32 v180, v180, v2
    v_mul_f32 v181, v181, v2
    v_cvt_pk_bf16_f32 v168, v168, v169
    v_cvt_pk_bf16_f32 v169, v170, v171
    v_cvt_pk_bf16_f32 v170, v172, v173
    v_cvt_pk_bf16_f32 v171, v174, v175
    v_cvt_pk_bf16_f32 v172, v176, v177
    v_cvt_pk_bf16_f32 v173, v178, v179
    v_cvt_pk_bf16_f32 v174, v180, v181
    v_mov_b32 v175, 0
    v_mfma_f32_32x32x16_bf16 v[72:87], v[8:11], v[168:171], v[72:87]
    v_cvt_pk_bf16_f32 v3, v198, v198
    v_and_b32 v3, 0xffff0000, v3
    v_add_f32 v3, s86, v3
    v_rcp_f32 v3, v3
    s_nop 0
    v_mul_f32 v184, v184, v3
    v_mfma_f32_32x32x16_bf16 v[88:103], v[16:19], v[168:171], 0
    v_mul_f32 v185, v185, v3
    v_mul_f32 v186, v186, v3
    v_mul_f32 v187, v187, v3
    v_mul_f32 v188, v188, v3
    v_mul_f32 v189, v189, v3
    v_mul_f32 v190, v190, v3
    v_mfma_f32_32x32x16_bf16 v[72:87], v[12:15], v[172:175], v[72:87]
    v_mul_f32 v191, v191, v3
    v_mul_f32 v192, v192, v3
    v_mul_f32 v193, v193, v3
    v_mul_f32 v194, v194, v3
    v_mul_f32 v195, v195, v3
    v_mul_f32 v196, v196, v3
    v_mfma_f32_32x32x16_bf16 v[88:103], v[20:23], v[172:175], v[88:103]
    v_mul_f32 v197, v197, v3
    v_cvt_pk_bf16_f32 v184, v184, v185
    v_cvt_pk_bf16_f32 v185, v186, v187
    v_cvt_pk_bf16_f32 v186, v188, v189
    v_cvt_pk_bf16_f32 v187, v190, v191
    v_cvt_pk_bf16_f32 v188, v192, v193
    v_cvt_pk_bf16_f32 v189, v194, v195
    v_cvt_pk_bf16_f32 v190, v196, v197
    v_mov_b32 v191, 0
    s_waitcnt vmcnt(12)
    v_cvt_pk_bf16_f32 v152, v152, v153
    v_cvt_pk_bf16_f32 v153, v154, v155
    v_cvt_pk_bf16_f32 v154, v156, v157
    v_cvt_pk_bf16_f32 v155, v158, v159
    v_cvt_pk_bf16_f32 v156, v160, v161
    v_cvt_pk_bf16_f32 v157, v162, v163
    v_cvt_pk_bf16_f32 v158, v164, v165
    v_cvt_pk_bf16_f32 v159, v166, v167
    s_waitcnt vmcnt(8)
    v_mfma_f32_32x32x16_bf16 v[200:215], v[152:155], a[240:243], 0
    v_mfma_f32_32x32x16_bf16 v[200:215], v[156:159], a[244:247], v[200:215]
    v_mfma_f32_32x32x16_bf16 v[216:231], v[152:155], a[248:251], 0
    v_mfma_f32_32x32x16_bf16 v[216:231], v[156:159], a[252:255], v[216:231]
    s_add_u32 s79, s76, 3
    s_and_b32 s79, s79, 3
    s_lshl_b32 s80, s79, 12
    s_add_u32 s80, s80, s6
    s_lshl_b32 s81, s79, 17
    s_add_u32 s81, s81, s7
    s_add_u32 s82, s81, s8
    s_xor_b32 s81, s82, 2048
    buffer_load_dwordx4 v[152:155], v240, s[56:59], s80 offen offset:0 sc1
    buffer_load_dwordx4 v[156:159], v240, s[56:59], s80 offen offset:1024 sc1
    buffer_load_dwordx4 v[160:163], v240, s[56:59], s80 offen offset:2048 sc1
    buffer_load_dwordx4 v[164:167], v240, s[56:59], s80 offen offset:3072 sc1
    buffer_load_dwordx4 a[240:243], v240, s[56:59], s82 offen offset:0 sc1
    buffer_load_dwordx4 a[244:247], v240, s[56:59], s82 offen offset:1024 sc1
    buffer_load_dwordx4 a[248:251], v240, s[56:59], s81 offen offset:0 sc1
    buffer_load_dwordx4 a[252:255], v240, s[56:59], s81 offen offset:1024 sc1
    v_mfma_f32_32x32x16_bf16 v[104:119], v[8:11], v[184:187], 0
    v_cvt_pk_bf16_f32 v2, v214, v214
    v_and_b32 v2, 0xffff0000, v2
    v_add_f32 v2, s86, v2
    v_rcp_f32 v2, v2
    s_nop 0
    v_mul_f32 v200, v200, v2
    v_mfma_f32_32x32x16_bf16 v[120:135], v[16:19], v[184:187], 0
    v_mul_f32 v201, v201, v2
    v_mul_f32 v202, v202, v2
    v_mul_f32 v203, v203, v2
    v_mul_f32 v204, v204, v2
    v_mul_f32 v205, v205, v2
    v_mul_f32 v206, v206, v2
    v_mfma_f32_32x32x16_bf16 v[104:119], v[12:15], v[188:191], v[104:119]
    v_mul_f32 v207, v207, v2
    v_mul_f32 v208, v208, v2
    v_mul_f32 v209, v209, v2
    v_mul_f32 v210, v210, v2
    v_mul_f32 v211, v211, v2
    v_mul_f32 v212, v212, v2
    v_mfma_f32_32x32x16_bf16 v[120:135], v[20:23], v[188:191], v[120:135]
    v_mul_f32 v213, v213, v2
    v_cvt_pk_bf16_f32 v200, v200, v201
    v_cvt_pk_bf16_f32 v201, v202, v203
    v_cvt_pk_bf16_f32 v202, v204, v205
    v_cvt_pk_bf16_f32 v203, v206, v207
    v_cvt_pk_bf16_f32 v204, v208, v209
    v_cvt_pk_bf16_f32 v205, v210, v211
    v_cvt_pk_bf16_f32 v206, v212, v213
    v_mov_b32 v207, 0
    v_mfma_f32_32x32x16_bf16 v[72:87], v[24:27], v[200:203], v[72:87]
    v_cvt_pk_bf16_f32 v3, v230, v230
    v_and_b32 v3, 0xffff0000, v3
    v_add_f32 v3, s86, v3
    v_rcp_f32 v3, v3
    s_nop 0
    v_mul_f32 v216, v216, v3
    v_mfma_f32_32x32x16_bf16 v[88:103], v[32:35], v[200:203], v[88:103]
    v_mul_f32 v217, v217, v3
    v_mul_f32 v218, v218, v3
    v_mul_f32 v219, v219, v3
    v_mul_f32 v220, v220, v3
    v_mul_f32 v221, v221, v3
    v_mul_f32 v222, v222, v3
    v_mfma_f32_32x32x16_bf16 v[72:87], v[28:31], v[204:207], v[72:87]
    v_mul_f32 v223, v223, v3
    v_mul_f32 v224, v224, v3
    v_mul_f32 v225, v225, v3
    v_mul_f32 v226, v226, v3
    v_mul_f32 v227, v227, v3
    v_mul_f32 v228, v228, v3
    v_mfma_f32_32x32x16_bf16 v[88:103], v[36:39], v[204:207], v[88:103]
    v_mul_f32 v229, v229, v3
    v_cvt_pk_bf16_f32 v216, v216, v217
    v_cvt_pk_bf16_f32 v217, v218, v219
    v_cvt_pk_bf16_f32 v218, v220, v221
    v_cvt_pk_bf16_f32 v219, v222, v223
    v_cvt_pk_bf16_f32 v220, v224, v225
    v_cvt_pk_bf16_f32 v221, v226, v227
    v_cvt_pk_bf16_f32 v222, v228, v229
    v_mov_b32 v223, 0
    s_waitcnt vmcnt(12)
    v_cvt_pk_bf16_f32 v136, v136, v137
    v_cvt_pk_bf16_f32 v137, v138, v139
    v_cvt_pk_bf16_f32 v138, v140, v141
    v_cvt_pk_bf16_f32 v139, v142, v143
    v_cvt_pk_bf16_f32 v140, v144, v145
    v_cvt_pk_bf16_f32 v141, v146, v147
    v_cvt_pk_bf16_f32 v142, v148, v149
    v_cvt_pk_bf16_f32 v143, v150, v151
    s_waitcnt vmcnt(8)
    v_mfma_f32_32x32x16_bf16 v[168:183], v[136:139], a[224:227], 0
    v_mfma_f32_32x32x16_bf16 v[168:183], v[140:143], a[228:231], v[168:183]
    v_mfma_f32_32x32x16_bf16 v[184:199], v[136:139], a[232:235], 0
    v_mfma_f32_32x32x16_bf16 v[184:199], v[140:143], a[236:239], v[184:199]
    v_mfma_f32_32x32x16_bf16 v[104:119], v[24:27], v[216:219], v[104:119]
    s_nop 8
    v_cvt_pk_bf16_f32 v2, v182, v182
    v_and_b32 v2, 0xffff0000, v2
    v_add_f32 v2, s86, v2
    v_rcp_f32 v2, v2
    s_nop 0
    v_mul_f32 v168, v168, v2
    v_mfma_f32_32x32x16_bf16 v[120:135], v[32:35], v[216:219], v[120:135]
    buffer_load_dwordx4 a[0:3], v240, s[56:59], s96 offen offset:0 sc1
    v_mul_f32 v169, v169, v2
    v_mul_f32 v170, v170, v2
    v_mul_f32 v171, v171, v2
    v_mul_f32 v172, v172, v2
    v_mul_f32 v173, v173, v2
    v_mul_f32 v174, v174, v2
    v_mfma_f32_32x32x16_bf16 v[104:119], v[28:31], v[220:223], v[104:119]
    v_mul_f32 v175, v175, v2
    v_mul_f32 v176, v176, v2
    v_mul_f32 v177, v177, v2
    v_mul_f32 v178, v178, v2
    v_mul_f32 v179, v179, v2
    buffer_load_dwordx4 a[112:115], v242, s[56:59], s96 offen offset:0 sc1
    v_mul_f32 v180, v180, v2
    v_mfma_f32_32x32x16_bf16 v[120:135], v[36:39], v[220:223], v[120:135]
    v_mul_f32 v181, v181, v2
    v_cvt_pk_bf16_f32 v168, v168, v169
    v_cvt_pk_bf16_f32 v169, v170, v171
    v_cvt_pk_bf16_f32 v170, v172, v173
    v_cvt_pk_bf16_f32 v171, v174, v175
    v_cvt_pk_bf16_f32 v172, v176, v177
    v_cvt_pk_bf16_f32 v173, v178, v179
    v_cvt_pk_bf16_f32 v174, v180, v181
    v_mov_b32 v175, 0
    v_mfma_f32_32x32x16_bf16 v[72:87], v[40:43], v[168:171], v[72:87]
    buffer_load_dwordx4 a[4:7], v240, s[56:59], s96 offen offset:1024 sc1
    v_cvt_pk_bf16_f32 v3, v198, v198
    v_and_b32 v3, 0xffff0000, v3
    v_add_f32 v3, s86, v3
    v_rcp_f32 v3, v3
    s_nop 0
    v_mul_f32 v184, v184, v3
    v_mfma_f32_32x32x16_bf16 v[88:103], v[48:51], v[168:171], v[88:103]
    v_mul_f32 v185, v185, v3
    v_mul_f32 v186, v186, v3
    v_mul_f32 v187, v187, v3
    v_mul_f32 v188, v188, v3
    v_mul_f32 v189, v189, v3
    buffer_load_dwordx4 a[116:119], v242, s[56:59], s96 offen offset:1024 sc1
    v_mul_f32 v190, v190, v3
    v_mfma_f32_32x32x16_bf16 v[72:87], v[44:47], v[172:175], v[72:87]
    v_mul_f32 v191, v191, v3
    v_mul_f32 v192, v192, v3
    v_mul_f32 v193, v193, v3
    v_mul_f32 v194, v194, v3
    v_mul_f32 v195, v195, v3
    v_mul_f32 v196, v196, v3
    v_mfma_f32_32x32x16_bf16 v[88:103], v[52:55], v[172:175], v[88:103]
    buffer_load_dwordx4 a[8:11], v240, s[56:59], s96 offen offset:2048 sc1
    v_mul_f32 v197, v197, v3
    v_cvt_pk_bf16_f32 v184, v184, v185
    v_cvt_pk_bf16_f32 v185, v186, v187
    v_cvt_pk_bf16_f32 v186, v188, v189
    v_cvt_pk_bf16_f32 v187, v190, v191
    v_cvt_pk_bf16_f32 v188, v192, v193
    v_cvt_pk_bf16_f32 v189, v194, v195
    v_cvt_pk_bf16_f32 v190, v196, v197
    v_mov_b32 v191, 0
    s_waitcnt vmcnt(9)
    v_cvt_pk_bf16_f32 v152, v152, v153
    v_cvt_pk_bf16_f32 v153, v154, v155
    v_cvt_pk_bf16_f32 v154, v156, v157
    v_cvt_pk_bf16_f32 v155, v158, v159
    v_cvt_pk_bf16_f32 v156, v160, v161
    v_cvt_pk_bf16_f32 v157, v162, v163
    v_cvt_pk_bf16_f32 v158, v164, v165
    v_cvt_pk_bf16_f32 v159, v166, v167
    buffer_load_dwordx4 a[120:123], v242, s[56:59], s96 offen offset:2048 sc1
    s_waitcnt vmcnt(6)
    v_mfma_f32_32x32x16_bf16 v[200:215], v[152:155], a[240:243], 0
    v_mfma_f32_32x32x16_bf16 v[200:215], v[156:159], a[244:247], v[200:215]
    v_mfma_f32_32x32x16_bf16 v[216:231], v[152:155], a[248:251], 0
    buffer_load_dwordx4 a[12:15], v240, s[56:59], s96 offen offset:3072 sc1
    v_mfma_f32_32x32x16_bf16 v[216:231], v[156:159], a[252:255], v[216:231]
    v_mfma_f32_32x32x16_bf16 v[104:119], v[40:43], v[184:187], v[104:119]
    s_nop 7
    v_cvt_pk_bf16_f32 v2, v214, v214
    v_and_b32 v2, 0xffff0000, v2
    v_add_f32 v2, s86, v2
    v_rcp_f32 v2, v2
    buffer_load_dwordx4 a[124:127], v242, s[56:59], s96 offen offset:3072 sc1
    v_mul_f32 v200, v200, v2
    v_mfma_f32_32x32x16_bf16 v[120:135], v[48:51], v[184:187], v[120:135]
    v_mul_f32 v201, v201, v2
    v_mul_f32 v202, v202, v2
    v_mul_f32 v203, v203, v2
    v_mul_f32 v204, v204, v2
    v_mul_f32 v205, v205, v2
    v_mul_f32 v206, v206, v2
    v_mfma_f32_32x32x16_bf16 v[104:119], v[44:47], v[188:191], v[104:119]
    buffer_load_dwordx4 a[16:19], v241, s[56:59], s96 offen offset:0 sc1
    v_mul_f32 v207, v207, v2
    v_mul_f32 v208, v208, v2
    v_mul_f32 v209, v209, v2
    v_mul_f32 v210, v210, v2
    v_mul_f32 v211, v211, v2
    v_mul_f32 v212, v212, v2
    v_mfma_f32_32x32x16_bf16 v[120:135], v[52:55], v[188:191], v[120:135]
    v_mul_f32 v213, v213, v2
    v_cvt_pk_bf16_f32 v200, v200, v201
    v_cvt_pk_bf16_f32 v201, v202, v203
    v_cvt_pk_bf16_f32 v202, v204, v205
    v_cvt_pk_bf16_f32 v203, v206, v207
    buffer_load_dwordx4 a[128:131], v243, s[56:59], s96 offen offset:0 sc1
    v_cvt_pk_bf16_f32 v204, v208, v209
    v_cvt_pk_bf16_f32 v205, v210, v211
    v_cvt_pk_bf16_f32 v206, v212, v213
    v_mov_b32 v207, 0
    v_mfma_f32_32x32x16_bf16 v[72:87], v[56:59], v[200:203], v[72:87]
    v_cvt_pk_bf16_f32 v3, v230, v230
    v_and_b32 v3, 0xffff0000, v3
    v_add_f32 v3, s86, v3
    v_rcp_f32 v3, v3
    s_nop 0
    v_mul_f32 v216, v216, v3
    v_mfma_f32_32x32x16_bf16 v[88:103], v[64:67], v[200:203], v[88:103]
    buffer_load_dwordx4 a[20:23], v241, s[56:59], s96 offen offset:1024 sc1
    v_mul_f32 v217, v217, v3
    v_mul_f32 v218, v218, v3
    v_mul_f32 v219, v219, v3
    v_mul_f32 v220, v220, v3
    v_mul_f32 v221, v221, v3
    v_mul_f32 v222, v222, v3
    v_mfma_f32_32x32x16_bf16 v[72:87], v[60:63], v[204:207], v[72:87]
    v_mul_f32 v223, v223, v3
    v_mul_f32 v224, v224, v3
    v_mul_f32 v225, v225, v3
    v_mul_f32 v226, v226, v3
    v_mul_f32 v227, v227, v3
    buffer_load_dwordx4 a[132:135], v243, s[56:59], s96 offen offset:1024 sc1
    v_mul_f32 v228, v228, v3
    v_mfma_f32_32x32x16_bf16 v[88:103], v[68:71], v[204:207], v[88:103]
    v_mul_f32 v229, v229, v3
    v_cvt_pk_bf16_f32 v216, v216, v217
    v_cvt_pk_bf16_f32 v217, v218, v219
    v_cvt_pk_bf16_f32 v218, v220, v221
    v_cvt_pk_bf16_f32 v219, v222, v223
    v_cvt_pk_bf16_f32 v220, v224, v225
    v_cvt_pk_bf16_f32 v221, v226, v227
    v_cvt_pk_bf16_f32 v222, v228, v229
    v_mov_b32 v223, 0
    v_mfma_f32_32x32x16_bf16 v[104:119], v[56:59], v[216:219], v[104:119]
    buffer_load_dwordx4 a[24:27], v241, s[56:59], s96 offen offset:2048 sc1
    v_mfma_f32_32x32x16_bf16 v[120:135], v[64:67], v[216:219], v[120:135]
    v_mfma_f32_32x32x16_bf16 v[104:119], v[60:63], v[220:223], v[104:119]
    v_mfma_f32_32x32x16_bf16 v[120:135], v[68:71], v[220:223], v[120:135]
    buffer_load_dwordx4 a[136:139], v243, s[56:59], s96 offen offset:2048 sc1
    ds_write_b128 v244, v[88:91] offset:0
    ds_write_b128 v244, v[92:95] offset:1024
    ds_write_b128 v244, v[96:99] offset:2048
    ds_write_b128 v244, v[100:103] offset:3072
    s_nop 5
    ds_write_b128 v245, v[104:107] offset:0
    ds_write_b128 v245, v[108:111] offset:1024
    ds_write_b128 v245, v[112:115] offset:2048
    buffer_load_dwordx4 a[28:31], v240, s[56:59], s97 offen offset:0 sc1
    ds_write_b128 v245, v[116:119] offset:3072
    ds_write_b128 v246, v[120:123] offset:0
    ds_write_b128 v246, v[124:127] offset:1024
    ds_write_b128 v246, v[128:131] offset:2048
    ds_write_b128 v246, v[132:135] offset:3072
    s_waitcnt lgkmcnt(0)
    s_barrier
    buffer_load_dwordx4 a[140:143], v242, s[56:59], s97 offen offset:0 sc1
    ds_read_b128 v[168:171], v247 offset:0
    ds_read_b128 v[184:187], v247 offset:4096
    ds_read_b128 v[200:203], v247 offset:8192
    ds_read_b128 v[172:175], v247 offset:1024
    ds_read_b128 v[188:191], v247 offset:5120
    buffer_load_dwordx4 a[32:35], v240, s[56:59], s97 offen offset:1024 sc1
    ds_read_b128 v[204:207], v247 offset:9216
    ds_read_b128 v[176:179], v247 offset:2048
    ds_read_b128 v[192:195], v247 offset:6144
    ds_read_b128 v[208:211], v247 offset:10240
    ds_read_b128 v[180:183], v247 offset:3072
    buffer_load_dwordx4 a[144:147], v242, s[56:59], s97 offen offset:1024 sc1
    ds_read_b128 v[196:199], v247 offset:7168
    ds_read_b128 v[212:215], v247 offset:11264
    s_waitcnt lgkmcnt(9)
    v_pk_add_f32 v[168:169], v[168:169], v[72:73]
    v_pk_add_f32 v[184:185], v[184:185], v[200:201]
    v_pk_add_f32 v[170:171], v[170:171], v[74:75]
    v_pk_add_f32 v[186:187], v[186:187], v[202:203]
    v_pk_add_f32 v[168:169], v[168:169], v[184:185]
    v_pk_add_f32 v[170:171], v[170:171], v[186:187]
    v_cvt_pk_bf16_f32 v232, v168, v169
    v_cvt_pk_bf16_f32 v233, v170, v171
    s_waitcnt lgkmcnt(6)
    v_pk_add_f32 v[172:173], v[172:173], v[76:77]
    buffer_load_dwordx4 a[36:39], v240, s[56:59], s97 offen offset:2048 sc1
    v_pk_add_f32 v[188:189], v[188:189], v[204:205]
    v_pk_add_f32 v[174:175], v[174:175], v[78:79]
    v_pk_add_f32 v[190:191], v[190:191], v[206:207]
    v_pk_add_f32 v[172:173], v[172:173], v[188:189]
    v_pk_add_f32 v[174:175], v[174:175], v[190:191]
    v_cvt_pk_bf16_f32 v234, v172, v173
    v_cvt_pk_bf16_f32 v235, v174, v175
    s_nop 0
    v_permlane32_swap_b32 v232, v234
    v_permlane32_swap_b32 v233, v235
    s_waitcnt lgkmcnt(3)
    v_pk_add_f32 v[176:177], v[176:177], v[80:81]
    v_pk_add_f32 v[192:193], v[192:193], v[208:209]
    v_pk_add_f32 v[178:179], v[178:179], v[82:83]
    v_pk_add_f32 v[194:195], v[194:195], v[210:211]
    v_pk_add_f32 v[176:177], v[176:177], v[192:193]
    v_pk_add_f32 v[178:179], v[178:179], v[194:195]
    v_cvt_pk_bf16_f32 v236, v176, v177
    v_cvt_pk_bf16_f32 v237, v178, v179
    buffer_load_dwordx4 a[148:151], v242, s[56:59], s97 offen offset:2048 sc1
    s_waitcnt lgkmcnt(0)
    v_pk_add_f32 v[180:181], v[180:181], v[84:85]
    v_pk_add_f32 v[196:197], v[196:197], v[212:213]
    v_pk_add_f32 v[182:183], v[182:183], v[86:87]
    v_pk_add_f32 v[198:199], v[198:199], v[214:215]
    v_pk_add_f32 v[180:181], v[180:181], v[196:197]
    v_pk_add_f32 v[182:183], v[182:183], v[198:199]
    v_cvt_pk_bf16_f32 v238, v180, v181
    v_cvt_pk_bf16_f32 v239, v182, v183
    s_nop 0
    v_permlane32_swap_b32 v236, v238
    v_permlane32_swap_b32 v237, v239
    s_mul_i32 s77, s4, 28
    s_lshl_b32 s78, s5, 1
    s_add_u32 s77, s77, s78
    s_lshl_b32 s77, s77, 10
    s_add_u32 s77, s77, 3145728
    buffer_store_dwordx4 v[232:235], v240, s[56:59], s77 offen offset:0 sc1
    buffer_store_dwordx4 v[236:239], v240, s[56:59], s77 offen offset:1024 sc1
    v_mov_b32 v2, 0
    v_mov_b32 v3, 0
    v_dot2c_f32_bf16 v2, s85, v232
    v_dot2c_f32_bf16 v3, v232, v232
    v_dot2c_f32_bf16 v2, s85, v233
    v_dot2c_f32_bf16 v3, v233, v233
    v_dot2c_f32_bf16 v2, s85, v234
    v_dot2c_f32_bf16 v3, v234, v234
    v_dot2c_f32_bf16 v2, s85, v235
    v_dot2c_f32_bf16 v3, v235, v235
    v_dot2c_f32_bf16 v2, s85, v236
    v_dot2c_f32_bf16 v3, v236, v236
    v_dot2c_f32_bf16 v2, s85, v237
    v_dot2c_f32_bf16 v3, v237, v237
    v_dot2c_f32_bf16 v2, s85, v238
    v_dot2c_f32_bf16 v3, v238, v238
    v_dot2c_f32_bf16 v2, s85, v239
    v_dot2c_f32_bf16 v3, v239, v239
    s_lshl_b32 s77, s5, 14
    s_lshl_b32 s78, s4, 8
    s_add_u32 s77, s77, s78
    s_add_u32 s77, s77, 4980736
    v_mov_b32 v4, v2
    v_mov_b32 v5, v3
    v_lshlrev_b32 v6, 3, v1
    v_permlane32_swap_b32 v2, v4
    v_permlane32_swap_b32 v3, v5
    v_add_f32 v8, v2, v4
    v_add_f32 v9, v3, v5
    s_mov_b32 exec_hi, 0
    buffer_store_dwordx2 v[8:9], v6, s[56:59], s77 offen sc1
    s_mov_b64 exec, -1
    buffer_load_dwordx4 a[40:43], v240, s[56:59], s97 offen offset:3072 sc1
    buffer_load_dwordx4 a[152:155], v242, s[56:59], s97 offen offset:3072 sc1
    buffer_load_dwordx4 a[44:47], v241, s[56:59], s97 offen offset:0 sc1
    buffer_load_dwordx4 a[156:159], v243, s[56:59], s97 offen offset:0 sc1
    buffer_load_dwordx4 a[48:51], v241, s[56:59], s97 offen offset:1024 sc1
    buffer_load_dwordx4 a[160:163], v243, s[56:59], s97 offen offset:1024 sc1
    buffer_load_dwordx4 a[52:55], v241, s[56:59], s97 offen offset:2048 sc1
    buffer_load_dwordx4 a[164:167], v243, s[56:59], s97 offen offset:2048 sc1
    buffer_load_dwordx4 a[56:59], v240, s[56:59], s98 offen offset:0 sc1
    buffer_load_dwordx4 a[168:171], v242, s[56:59], s98 offen offset:0 sc1
    s_lshr_b32 s82, s72, 1
    s_lshl_b32 s83, s82, 8
    s_add_u32 s83, s83, 2232320
    s_waitcnt vmcnt(10)
    s_barrier
    v_mov_b32 v2, 1
    v_mov_b32 v3, 0
    s_mov_b64 exec, 1
    buffer_atomic_add v2, v3, s[60:63], s83 offen sc1
    s_mov_b64 exec, -1
    s_lshl_b32 s80, s75, 2
    s_add_u32 s80, s80, s68
    s_lshl_b32 s80, s80, 8
    s_add_u32 s80, s80, 2883584
    v_and_b32 v2, 31, v1
    v_lshlrev_b32 v3, 2, v2
    buffer_load_dword v252, v3, s[56:59], s80 offen offset:0 sc1
    buffer_load_dword v253, v3, s[56:59], s80 offen offset:128 sc1
    buffer_load_dwordx4 a[60:63], v240, s[56:59], s98 offen offset:1024 sc1
    buffer_load_dwordx4 a[172:175], v242, s[56:59], s98 offen offset:1024 sc1
    buffer_load_dwordx4 a[64:67], v240, s[56:59], s98 offen offset:2048 sc1
    buffer_load_dwordx4 a[176:179], v242, s[56:59], s98 offen offset:2048 sc1
    buffer_load_dwordx4 a[68:71], v240, s[56:59], s98 offen offset:3072 sc1
    buffer_load_dwordx4 a[180:183], v242, s[56:59], s98 offen offset:3072 sc1
    buffer_load_dwordx4 a[72:75], v241, s[56:59], s98 offen offset:0 sc1
    buffer_load_dwordx4 a[184:187], v243, s[56:59], s98 offen offset:0 sc1
    buffer_load_dwordx4 a[76:79], v241, s[56:59], s98 offen offset:1024 sc1
    buffer_load_dwordx4 a[188:191], v243, s[56:59], s98 offen offset:1024 sc1
    buffer_load_dwordx4 a[80:83], v241, s[56:59], s98 offen offset:2048 sc1
    buffer_load_dwordx4 a[192:195], v243, s[56:59], s98 offen offset:2048 sc1
    buffer_load_dwordx4 a[84:87], v240, s[56:59], s99 offen offset:0 sc1
    buffer_load_dwordx4 a[196:199], v242, s[56:59], s99 offen offset:0 sc1
    buffer_load_dwordx4 a[88:91], v240, s[56:59], s99 offen offset:1024 sc1
    buffer_load_dwordx4 a[200:203], v242, s[56:59], s99 offen offset:1024 sc1
    buffer_load_dwordx4 a[92:95], v240, s[56:59], s99 offen offset:2048 sc1
    buffer_load_dwordx4 a[204:207], v242, s[56:59], s99 offen offset:2048 sc1
    buffer_load_dwordx4 a[96:99], v240, s[56:59], s99 offen offset:3072 sc1
    buffer_load_dwordx4 a[208:211], v242, s[56:59], s99 offen offset:3072 sc1
    buffer_load_dwordx4 a[100:103], v241, s[56:59], s99 offen offset:0 sc1
    buffer_load_dwordx4 a[212:215], v243, s[56:59], s99 offen offset:0 sc1
    buffer_load_dwordx4 a[104:107], v241, s[56:59], s99 offen offset:1024 sc1
    buffer_load_dwordx4 a[216:219], v243, s[56:59], s99 offen offset:1024 sc1
    buffer_load_dwordx4 a[108:111], v241, s[56:59], s99 offen offset:2048 sc1
    buffer_load_dwordx4 a[220:223], v243, s[56:59], s99 offen offset:2048 sc1
    s_mul_i32 s80, s5, 112
    s_mul_i32 s81, s68, 28
    s_add_u32 s80, s80, s81
    s_lshl_b32 s80, s80, 10
    s_add_u32 s80, s80, 9437184
    s_add_u32 s81, s76, 0
    s_and_b32 s81, s81, 3
    s_mul_i32 s82, s81, 7168
    v_add_u32 v124, s82, v240
    v_add_u32 v128, 57344, v124
    s_add_u32 s19, s82, s80
    s_add_u32 s81, s76, 1
    s_and_b32 s81, s81, 3
    s_mul_i32 s82, s81, 7168
    v_add_u32 v125, s82, v240
    v_add_u32 v129, 57344, v125
    s_add_u32 s20, s82, s80
    s_add_u32 s81, s76, 2
    s_and_b32 s81, s81, 3
    s_mul_i32 s82, s81, 7168
    v_add_u32 v126, s82, v240
    v_add_u32 v130, 57344, v126
    s_add_u32 s21, s82, s80
    s_add_u32 s81, s76, 3
    s_and_b32 s81, s81, 3
    s_mul_i32 s82, s81, 7168
    v_add_u32 v127, s82, v240
    v_add_u32 v131, 57344, v127
    s_add_u32 s22, s82, s80
    s_and_b32 s81, s5, 1
    s_mul_i32 s81, s81, 114688
    s_sub_u32 s82, 114688, s81
    s_sub_u32 s19, s19, s81
    s_sub_u32 s20, s20, s81
    s_sub_u32 s21, s21, s81
    s_sub_u32 s22, s22, s81
    s_lshr_b32 s83, s68, 1
    s_lshl_b32 s83, s83, 8
    v_xor_b32 v2, s83, v240
    v_add_u32 v152, s81, v2
    v_add_u32 v153, 4096, v152
    v_add_u32 v154, s82, v2
    v_add_u32 v155, 4096, v154
    s_mul_i32 s9, s74, 114688
    s_mul_i32 s10, s68, 7168
    s_add_u32 s9, s9, s10
    s_add_u32 s9, s9, 3145728
    s_lshl_b32 s79, s75, 3
    s_lshl_b32 s80, s68, 1
    s_add_u32 s79, s79, s80
    s_mul_i32 s77, s74, 448
    s_add_u32 s77, s77, s79
    s_lshl_b32 s77, s77, 10
    s_add_u32 s77, s77, 11534336
    s_add_u32 s11, s77, 0
    s_add_u32 s12, s77, 114688
    s_add_u32 s13, s77, 229376
    s_add_u32 s14, s77, 344064
    v_and_b32 v2, 31, v1
    v_lshrrev_b32 v3, 5, v1
    v_mul_u32_u24 v116, 114688, v3
    v_lshl_add_u32 v116, v2, 3, v116
    s_lshl_b32 s77, s74, 2
    s_add_u32 s77, s77, s68
    s_lshl_b32 s78, s77, 8
    s_add_u32 s78, s78, 4980736
    s_lshl_b32 s79, s74, 8
    s_add_u32 s79, s79, 2232320
    v_mov_b32 v249, s79
    s_mov_b32 s94, 0
    s_nop 1
kf_p2:
    buffer_load_dword v248, v249, s[56:59], 0 offen sc1
    s_add_u32 s94, s94, 1
    s_waitcnt vmcnt(0)
kf_p2_chk:
    v_cmp_le_u32 vcc, 14, v248
    s_cmp_ge_u32 s94, 524288
    s_nop 3
    s_cbranch_scc1 kf_p2_ok
    s_and_b32 s84, vcc_lo, 1
    s_cmp_eq_u32 s84, 1
    s_cbranch_scc1 kf_p2_ok
    s_sleep 1
    s_branch kf_p2
kf_p2_ok:
    s_add_u32 s80, s9, 0
    s_add_u32 m0, s10, 0
    s_nop 0
    buffer_load_dwordx4 v240, s[56:59], s80 offen offset:0 sc1 lds
    buffer_load_dwordx4 v240, s[56:59], s80 offen offset:1024 sc1 lds
    buffer_load_dwordx4 v240, s[56:59], s80 offen offset:2048 sc1 lds
    buffer_load_dwordx4 v240, s[56:59], s80 offen offset:3072 sc1 lds
    s_add_u32 s80, s9, 4096
    s_add_u32 m0, s10, 4096
    s_nop 0
    buffer_load_dwordx4 v240, s[56:59], s80 offen offset:0 sc1 lds
    buffer_load_dwordx4 v240, s[56:59], s80 offen offset:1024 sc1 lds
    buffer_load_dwordx4 v240, s[56:59], s80 offen offset:2048 sc1 lds
    buffer_load_dwordx2 v[156:157], v116, s[56:59], s78 offen sc1
    s_add_u32 s78, s78, 16384
    buffer_load_dwordx2 v[158:159], v116, s[56:59], s78 offen sc1
    s_add_u32 s78, s78, 16384
    buffer_load_dwordx2 v[160:161], v116, s[56:59], s78 offen sc1
    s_add_u32 s78, s78, 16384
    buffer_load_dwordx2 v[162:163], v116, s[56:59], s78 offen sc1
    s_add_u32 s78, s78, 16384
    buffer_load_dwordx2 v[164:165], v116, s[56:59], s78 offen sc1
    s_add_u32 s78, s78, 16384
    buffer_load_dwordx2 v[166:167], v116, s[56:59], s78 offen sc1
    s_add_u32 s78, s78, 16384
    buffer_load_dwordx2 v[168:169], v116, s[56:59], s78 offen sc1
    v_mov_b32 v4, v252
    v_cvt_pk_bf16_f32 v5, v4, v4
    v_and_b32 v5, 0xffff0000, v5
    v_sub_f32 v6, v4, v5
    v_cvt_pk_bf16_f32 v132, v4, v6
    v_and_b32 v5, 0xffff0000, v132
    v_sub_f32 v6, v6, v5
    v_cvt_pk_bf16_f32 v133, v6, 0
    v_cndmask_b32 v132, 0, v132, s[90:91]
    v_cndmask_b32 v133, 0, v133, s[90:91]
    v_mov_b32 v134, 0
    v_mov_b32 v135, 0
    v_mov_b32 v4, v253
    v_cvt_pk_bf16_f32 v5, v4, v4
    v_and_b32 v5, 0xffff0000, v5
    v_sub_f32 v6, v4, v5
    v_cvt_pk_bf16_f32 v136, v4, v6
    v_and_b32 v5, 0xffff0000, v136
    v_sub_f32 v6, v6, v5
    v_cvt_pk_bf16_f32 v137, v6, 0
    v_cndmask_b32 v136, 0, v136, s[90:91]
    v_cndmask_b32 v137, 0, v137, s[90:91]
    v_mov_b32 v138, 0
    v_mov_b32 v139, 0
    s_lshl_b32 s79, s68, 8
    s_add_u32 s79, s79, 2248704
    v_mov_b32 v249, s79
    s_waitcnt vmcnt(7)
    s_barrier
    ds_read_b128 v[72:75], v124 offset:0
    ds_read_b128 v[76:79], v124 offset:1024
    ds_read_b128 v[80:83], v124 offset:2048
    ds_read_b128 v[84:87], v124 offset:3072
    ds_read_b128 v[88:91], v124 offset:4096
    ds_read_b128 v[92:95], v124 offset:5120
    s_waitcnt lgkmcnt(5)
    v_mfma_f32_32x32x16_bf16 v[8:23], a[0:3], v[72:75], 0
    buffer_load_dword v248, v249, s[56:59], 0 offen sc1
    v_mfma_f32_32x32x16_bf16 v[24:39], a[112:115], v[72:75], 0
    ds_read_b128 v[72:75], v124 offset:6144
    s_waitcnt lgkmcnt(5)
    v_mfma_f32_32x32x16_bf16 v[8:23], a[4:7], v[76:79], v[8:23]
    s_add_u32 s80, s9, 28672
    s_add_u32 m0, s10, 28672
    s_nop 0
    buffer_load_dwordx4 v240, s[56:59], s80 offen offset:0 sc1 lds
    v_mfma_f32_32x32x16_bf16 v[24:39], a[116:119], v[76:79], v[24:39]
    ds_read_b128 v[76:79], v125 offset:0
    s_waitcnt lgkmcnt(5)
    v_mfma_f32_32x32x16_bf16 v[8:23], a[8:11], v[80:83], v[8:23]
    s_add_u32 s80, s9, 28672
    s_add_u32 m0, s10, 28672
    s_nop 0
    buffer_load_dwordx4 v240, s[56:59], s80 offen offset:1024 sc1 lds
    v_mfma_f32_32x32x16_bf16 v[24:39], a[120:123], v[80:83], v[24:39]
    ds_read_b128 v[80:83], v125 offset:1024
    s_waitcnt lgkmcnt(5)
    v_mfma_f32_32x32x16_bf16 v[8:23], a[12:15], v[84:87], v[8:23]
    s_add_u32 s80, s9, 28672
    s_add_u32 m0, s10, 28672
    s_nop 0
    buffer_load_dwordx4 v240, s[56:59], s80 offen offset:2048 sc1 lds
    v_mfma_f32_32x32x16_bf16 v[24:39], a[124:127], v[84:87], v[24:39]
    ds_read_b128 v[84:87], v125 offset:2048
    s_waitcnt lgkmcnt(5)
    v_mfma_f32_32x32x16_bf16 v[8:23], a[16:19], v[88:91], v[8:23]
    s_add_u32 s80, s9, 28672
    s_add_u32 m0, s10, 28672
    s_nop 0
    buffer_load_dwordx4 v240, s[56:59], s80 offen offset:3072 sc1 lds
    v_mfma_f32_32x32x16_bf16 v[24:39], a[128:131], v[88:91], v[24:39]
    ds_read_b128 v[88:91], v125 offset:3072
    s_waitcnt lgkmcnt(5)
    v_mfma_f32_32x32x16_bf16 v[8:23], a[20:23], v[92:95], v[8:23]
    s_add_u32 s80, s9, 32768
    s_add_u32 m0, s10, 32768
    s_nop 0
    buffer_load_dwordx4 v240, s[56:59], s80 offen offset:0 sc1 lds
    v_mfma_f32_32x32x16_bf16 v[24:39], a[132:135], v[92:95], v[24:39]
    ds_read_b128 v[92:95], v125 offset:4096
    s_waitcnt lgkmcnt(5)
    v_mfma_f32_32x32x16_bf16 v[8:23], a[24:27], v[72:75], v[8:23]
    s_add_u32 s80, s9, 32768
    s_add_u32 m0, s10, 32768
    s_nop 0
    buffer_load_dwordx4 v240, s[56:59], s80 offen offset:1024 sc1 lds
    v_mfma_f32_32x32x16_bf16 v[24:39], a[136:139], v[72:75], v[24:39]
    ds_read_b128 v[72:75], v125 offset:5120
    s_waitcnt lgkmcnt(5)
    v_mfma_f32_32x32x16_bf16 v[8:23], a[28:31], v[76:79], v[8:23]
    s_add_u32 s80, s9, 32768
    s_add_u32 m0, s10, 32768
    s_nop 0
    buffer_load_dwordx4 v240, s[56:59], s80 offen offset:2048 sc1 lds
    s_waitcnt vmcnt(8)
    v_mfma_f32_32x32x16_bf16 v[24:39], a[140:143], v[76:79], v[24:39]
    v_add_f32 v156, v156, v158
    v_add_f32 v157, v157, v159
    ds_read_b128 v[76:79], v125 offset:6144
    s_waitcnt lgkmcnt(5)
    v_mfma_f32_32x32x16_bf16 v[8:23], a[32:35], v[80:83], v[8:23]
    v_add_f32 v156, v156, v160
    v_add_f32 v157, v157, v161
    v_add_f32 v156, v156, v162
    v_add_f32 v157, v157, v163
    v_add_f32 v156, v156, v164
    v_add_f32 v157, v157, v165
    v_mfma_f32_32x32x16_bf16 v[24:39], a[144:147], v[80:83], v[24:39]
    v_add_f32 v156, v156, v166
    v_add_f32 v157, v157, v167
    ds_read_b128 v[80:83], v126 offset:0
    s_waitcnt lgkmcnt(5)
    v_mfma_f32_32x32x16_bf16 v[8:23], a[36:39], v[84:87], v[8:23]
    v_add_f32 v156, v156, v168
    v_add_f32 v157, v157, v169
    v_mov_b32 v5, v156
    v_mov_b32 v6, v157
    s_lshl_b32 s78, s68, 9
    s_add_u32 s78, s78, 114688
    v_mfma_f32_32x32x16_bf16 v[24:39], a[148:151], v[84:87], v[24:39]
    v_permlane32_swap_b32 v156, v5
    v_permlane32_swap_b32 v157, v6
    ds_read_b128 v[84:87], v126 offset:1024
    s_waitcnt lgkmcnt(5)
    v_mfma_f32_32x32x16_bf16 v[8:23], a[40:43], v[88:91], v[8:23]
    v_add_f32 v156, v156, v5
    v_add_f32 v157, v157, v6
    v_mul_f32 v5, 0x3b124925, v156
    v_mul_f32 v6, 0x3b124925, v157
    v_fma_f32 v6, -v5, v5, v6
    v_mfma_f32_32x32x16_bf16 v[24:39], a[152:155], v[88:91], v[24:39]
    v_max_f32 v6, 0, v6
    ds_read_b128 v[88:91], v126 offset:2048
    s_waitcnt lgkmcnt(5)
    v_mfma_f32_32x32x16_bf16 v[8:23], a[44:47], v[92:95], v[8:23]
    v_cvt_pk_bf16_f32 v3, v5, v5
    v_and_b32 v3, 0xffff0000, v3
    v_cvt_pk_bf16_f32 v6, v6, v6
    v_and_b32 v6, 0xffff0000, v6
    v_mfma_f32_32x32x16_bf16 v[24:39], a[156:159], v[92:95], v[24:39]
    v_add_f32 v6, 0x3727c5ac, v6
    ds_read_b128 v[92:95], v126 offset:3072
    s_waitcnt lgkmcnt(5)
    v_mfma_f32_32x32x16_bf16 v[8:23], a[48:51], v[72:75], v[8:23]
    v_cvt_pk_bf16_f32 v6, v6, v6
    v_and_b32 v6, 0xffff0000, v6
    v_sqrt_f32 v6, v6
    s_nop 0
    v_cvt_pk_bf16_f32 v6, v6, v6
    v_mfma_f32_32x32x16_bf16 v[24:39], a[160:163], v[72:75], v[24:39]
    v_and_b32 v6, 0xffff0000, v6
    ds_read_b128 v[72:75], v126 offset:4096
    s_waitcnt lgkmcnt(5)
    v_mfma_f32_32x32x16_bf16 v[8:23], a[52:55], v[76:79], v[8:23]
    v_rcp_f32 v7, v6
    v_sub_f32 v3, 0, v3
    v_cvt_pk_bf16_f32 v160, v3, v3
    v_mov_b32 v161, v160
    v_mfma_f32_32x32x16_bf16 v[24:39], a[164:167], v[76:79], v[24:39]
    v_mul_f32 v162, 0xbfb8aa3b, v7
    ds_read_b128 v[76:79], v126 offset:5120
    s_waitcnt lgkmcnt(5)
    v_mfma_f32_32x32x16_bf16 v[8:23], a[56:59], v[80:83], v[8:23]
    v_mul_f32 v163, v6, v6
    v_lshlrev_b32 v4, 4, v2
    v_add_u32 v5, s78, v4
    v_add_u32 v4, 114688, v4
    ds_write_b128 v5, v[160:163]
    v_mfma_f32_32x32x16_bf16 v[24:39], a[168:171], v[80:83], v[24:39]
    ds_read_b128 v[80:83], v126 offset:6144
    s_waitcnt lgkmcnt(6)
    v_mfma_f32_32x32x16_bf16 v[8:23], a[60:63], v[84:87], v[8:23]
    s_add_u32 s80, s9, 57344
    s_add_u32 m0, s10, 57344
    s_nop 0
    buffer_load_dwordx4 v240, s[56:59], s80 offen offset:0 sc1 lds
    v_mfma_f32_32x32x16_bf16 v[24:39], a[172:175], v[84:87], v[24:39]
    ds_read_b128 v[84:87], v127 offset:0
    s_waitcnt lgkmcnt(6)
    v_mfma_f32_32x32x16_bf16 v[8:23], a[64:67], v[88:91], v[8:23]
    s_add_u32 s80, s9, 57344
    s_add_u32 m0, s10, 57344
    s_nop 0
    buffer_load_dwordx4 v240, s[56:59], s80 offen offset:1024 sc1 lds
    v_mfma_f32_32x32x16_bf16 v[24:39], a[176:179], v[88:91], v[24:39]
    ds_read_b128 v[88:91], v127 offset:1024
    s_waitcnt lgkmcnt(6)
    v_mfma_f32_32x32x16_bf16 v[8:23], a[68:71], v[92:95], v[8:23]
    s_add_u32 s80, s9, 57344
    s_add_u32 m0, s10, 57344
    s_nop 0
    buffer_load_dwordx4 v240, s[56:59], s80 offen offset:2048 sc1 lds
    v_mfma_f32_32x32x16_bf16 v[24:39], a[180:183], v[92:95], v[24:39]
    ds_read_b128 v[92:95], v127 offset:2048
    s_waitcnt lgkmcnt(6)
    v_mfma_f32_32x32x16_bf16 v[8:23], a[72:75], v[72:75], v[8:23]
    s_add_u32 s80, s9, 57344
    s_add_u32 m0, s10, 57344
    s_nop 0
    buffer_load_dwordx4 v240, s[56:59], s80 offen offset:3072 sc1 lds
    v_mfma_f32_32x32x16_bf16 v[24:39], a[184:187], v[72:75], v[24:39]
    ds_read_b128 v[72:75], v127 offset:3072
    s_waitcnt lgkmcnt(6)
    v_mfma_f32_32x32x16_bf16 v[8:23], a[76:79], v[76:79], v[8:23]
    s_add_u32 s80, s9, 61440
    s_add_u32 m0, s10, 61440
    s_nop 0
    buffer_load_dwordx4 v240, s[56:59], s80 offen offset:0 sc1 lds
    v_mfma_f32_32x32x16_bf16 v[24:39], a[188:191], v[76:79], v[24:39]
    ds_read_b128 v[76:79], v127 offset:4096
    s_waitcnt lgkmcnt(5)
    v_mfma_f32_32x32x16_bf16 v[8:23], a[80:83], v[80:83], v[8:23]
    s_add_u32 s80, s9, 61440
    s_add_u32 m0, s10, 61440
    s_nop 0
    buffer_load_dwordx4 v240, s[56:59], s80 offen offset:1024 sc1 lds
    v_mfma_f32_32x32x16_bf16 v[24:39], a[192:195], v[80:83], v[24:39]
    ds_read_b128 v[80:83], v127 offset:5120
    s_waitcnt lgkmcnt(5)
    v_mfma_f32_32x32x16_bf16 v[8:23], a[84:87], v[84:87], v[8:23]
    s_add_u32 s80, s9, 61440
    s_add_u32 m0, s10, 61440
    s_nop 0
    buffer_load_dwordx4 v240, s[56:59], s80 offen offset:2048 sc1 lds
    v_mfma_f32_32x32x16_bf16 v[24:39], a[196:199], v[84:87], v[24:39]
    ds_read_b128 v[84:87], v127 offset:6144
    s_waitcnt lgkmcnt(5)
    v_mfma_f32_32x32x16_bf16 v[8:23], a[88:91], v[88:91], v[8:23]
    s_add_u32 s80, s9, 86016
    s_add_u32 m0, s10, 86016
    s_nop 0
    buffer_load_dwordx4 v240, s[56:59], s80 offen offset:0 sc1 lds
    v_mfma_f32_32x32x16_bf16 v[24:39], a[200:203], v[88:91], v[24:39]
    s_waitcnt vmcnt(8) lgkmcnt(8)
    s_barrier
    ds_read_b64 v[96:97], v4 offset:0
    ds_read_b64 v[108:109], v4 offset:8
    ds_read_b64 v[98:99], v4 offset:512
    ds_read_b64 v[110:111], v4 offset:520
    ds_read_b64 v[100:101], v4 offset:1024
    ds_read_b64 v[112:113], v4 offset:1032
    ds_read_b64 v[102:103], v4 offset:1536
    ds_read_b64 v[114:115], v4 offset:1544
    v_mov_b32 v104, 0
    v_mov_b32 v105, 0
    ds_read_b128 v[88:91], v124 offset:28672
    s_waitcnt lgkmcnt(13)
    v_mfma_f32_32x32x16_bf16 v[8:23], a[92:95], v[92:95], v[8:23]
    s_add_u32 s80, s9, 86016
    s_add_u32 m0, s10, 86016
    s_nop 0
    buffer_load_dwordx4 v240, s[56:59], s80 offen offset:1024 sc1 lds
    v_mfma_f32_32x32x16_bf16 v[24:39], a[204:207], v[92:95], v[24:39]
    ds_read_b128 v[92:95], v124 offset:29696
    s_waitcnt lgkmcnt(13)
    v_mfma_f32_32x32x16_bf16 v[8:23], a[96:99], v[72:75], v[8:23]
    s_add_u32 s80, s9, 86016
    s_add_u32 m0, s10, 86016
    s_nop 0
    buffer_load_dwordx4 v240, s[56:59], s80 offen offset:2048 sc1 lds
    v_mfma_f32_32x32x16_bf16 v[24:39], a[208:211], v[72:75], v[24:39]
    ds_read_b128 v[72:75], v124 offset:30720
    s_waitcnt lgkmcnt(13)
    v_mfma_f32_32x32x16_bf16 v[8:23], a[100:103], v[76:79], v[8:23]
    s_add_u32 s80, s9, 86016
    s_add_u32 m0, s10, 86016
    s_nop 0
    buffer_load_dwordx4 v240, s[56:59], s80 offen offset:3072 sc1 lds
    v_mfma_f32_32x32x16_bf16 v[24:39], a[212:215], v[76:79], v[24:39]
    ds_read_b128 v[76:79], v124 offset:31744
    s_waitcnt lgkmcnt(13)
    v_mfma_f32_32x32x16_bf16 v[8:23], a[104:107], v[80:83], v[8:23]
    s_add_u32 s80, s9, 90112
    s_add_u32 m0, s10, 90112
    s_nop 0
    buffer_load_dwordx4 v240, s[56:59], s80 offen offset:0 sc1 lds
    v_mfma_f32_32x32x16_bf16 v[24:39], a[216:219], v[80:83], v[24:39]
    ds_read_b128 v[80:83], v124 offset:32768
    s_waitcnt lgkmcnt(13)
    v_mfma_f32_32x32x16_bf16 v[8:23], a[108:111], v[84:87], v[8:23]
    s_add_u32 s80, s9, 90112
    s_add_u32 m0, s10, 90112
    s_nop 0
    buffer_load_dwordx4 v240, s[56:59], s80 offen offset:1024 sc1 lds
    v_mfma_f32_32x32x16_bf16 v[24:39], a[220:223], v[84:87], v[24:39]
    s_waitcnt lgkmcnt(5)
    v_mfma_f32_32x32x16_bf16 v[8:23], v[132:135], v[96:99], v[8:23]
    v_mfma_f32_32x32x16_bf16 v[24:39], v[136:139], v[96:99], v[24:39]
    s_add_u32 s80, s9, 90112
    s_add_u32 m0, s10, 90112
    s_nop 0
    buffer_load_dwordx4 v240, s[56:59], s80 offen offset:2048 sc1 lds
    s_mov_b32 s94, 0
    s_waitcnt vmcnt(21)
    s_nop 5
    s_branch kf_pw_chk
kf_pw:
    buffer_load_dword v248, v249, s[56:59], 0 offen sc1
    s_add_u32 s94, s94, 1
    s_waitcnt vmcnt(0)
kf_pw_chk:
    v_cmp_le_u32 vcc, 7, v248
    s_cmp_ge_u32 s94, 524288
    s_nop 3
    s_cbranch_scc1 kf_pw_ok
    s_and_b32 s84, vcc_lo, 1
    s_cmp_eq_u32 s84, 1
    s_cbranch_scc1 kf_pw_ok
    s_sleep 1
    s_branch kf_pw
kf_pw_ok:
    ds_read_b128 v[84:87], v124 offset:33792
    s_waitcnt lgkmcnt(5)
    v_mfma_f32_32x32x16_bf16 v[40:55], a[0:3], v[88:91], 0
    v_mfma_f32_32x32x16_bf16 v[56:71], a[112:115], v[88:91], 0
    ds_read_b128 v[88:91], v124 offset:34816
    s_waitcnt lgkmcnt(5)
    v_mfma_f32_32x32x16_bf16 v[40:55], a[4:7], v[92:95], v[40:55]
    v_mul_f32 v116, v108, v8
    v_mul_f32 v117, v108, v9
    v_mul_f32 v118, v108, v10
    v_mul_f32 v119, v108, v11
    v_mul_f32 v120, v108, v12
    v_mul_f32 v121, v108, v13
    v_mfma_f32_32x32x16_bf16 v[56:71], a[116:119], v[92:95], v[56:71]
    v_mul_f32 v122, v108, v14
    v_mul_f32 v123, v108, v15
    ds_read_b128 v[92:95], v125 offset:28672
    s_waitcnt lgkmcnt(5)
    v_mfma_f32_32x32x16_bf16 v[40:55], a[8:11], v[72:75], v[40:55]
    v_exp_f32 v116, v116
    v_mul_f32 v8, v8, v16
    v_exp_f32 v117, v117
    v_mul_f32 v9, v9, v17
    v_mfma_f32_32x32x16_bf16 v[56:71], a[120:123], v[72:75], v[56:71]
    buffer_load_dwordx4 v[140:143], v152, s[56:59], s19 offen offset:0 sc1
    ds_read_b128 v[72:75], v125 offset:29696
    s_waitcnt lgkmcnt(5)
    v_mfma_f32_32x32x16_bf16 v[40:55], a[12:15], v[76:79], v[40:55]
    v_exp_f32 v118, v118
    v_mul_f32 v10, v10, v18
    v_exp_f32 v119, v119
    v_mfma_f32_32x32x16_bf16 v[56:71], a[124:127], v[76:79], v[56:71]
    v_mul_f32 v11, v11, v19
    ds_read_b128 v[76:79], v125 offset:30720
    s_waitcnt lgkmcnt(5)
    v_mfma_f32_32x32x16_bf16 v[40:55], a[16:19], v[80:83], v[40:55]
    v_exp_f32 v120, v120
    v_mul_f32 v12, v12, v20
    v_exp_f32 v121, v121
    v_mul_f32 v13, v13, v21
    v_mfma_f32_32x32x16_bf16 v[56:71], a[128:131], v[80:83], v[56:71]
    buffer_load_dwordx4 v[144:147], v154, s[56:59], s19 offen offset:0 sc1
    ds_read_b128 v[80:83], v125 offset:31744
    s_waitcnt lgkmcnt(5)
    v_mfma_f32_32x32x16_bf16 v[40:55], a[20:23], v[84:87], v[40:55]
    v_exp_f32 v122, v122
    v_mul_f32 v14, v14, v22
    v_exp_f32 v123, v123
    v_mul_f32 v15, v15, v23
    v_mfma_f32_32x32x16_bf16 v[56:71], a[132:135], v[84:87], v[56:71]
    v_fma_f32 v116, v116, v109, v109
    ds_read_b128 v[84:87], v125 offset:32768
    s_waitcnt lgkmcnt(5)
    v_mfma_f32_32x32x16_bf16 v[40:55], a[24:27], v[88:91], v[40:55]
    v_fma_f32 v117, v117, v109, v109
    v_fma_f32 v118, v118, v109, v109
    v_fma_f32 v119, v119, v109, v109
    v_fma_f32 v120, v120, v109, v109
    v_mfma_f32_32x32x16_bf16 v[56:71], a[136:139], v[88:91], v[56:71]
    buffer_load_dwordx4 v[148:151], v152, s[56:59], s19 offen offset:1024 sc1
    ds_read_b128 v[88:91], v125 offset:33792
    s_waitcnt lgkmcnt(5)
    v_mfma_f32_32x32x16_bf16 v[40:55], a[28:31], v[92:95], v[40:55]
    v_fma_f32 v121, v121, v109, v109
    v_fma_f32 v122, v122, v109, v109
    v_fma_f32 v123, v123, v109, v109
    v_rcp_f32 v116, v116
    v_mfma_f32_32x32x16_bf16 v[56:71], a[140:143], v[92:95], v[56:71]
    buffer_load_dwordx4 a[224:227], v154, s[56:59], s19 offen offset:1024 sc1
    ds_read_b128 v[92:95], v125 offset:34816
    s_waitcnt lgkmcnt(5)
    v_mfma_f32_32x32x16_bf16 v[40:55], a[32:35], v[72:75], v[40:55]
    v_rcp_f32 v117, v117
    v_mul_f32 v8, v8, v116
    v_rcp_f32 v118, v118
    v_mul_f32 v9, v9, v117
    v_mfma_f32_32x32x16_bf16 v[56:71], a[144:147], v[72:75], v[56:71]
    v_rcp_f32 v119, v119
    ds_read_b128 v[72:75], v126 offset:28672
    s_waitcnt lgkmcnt(5)
    v_mfma_f32_32x32x16_bf16 v[40:55], a[36:39], v[76:79], v[40:55]
    v_mul_f32 v10, v10, v118
    v_rcp_f32 v120, v120
    v_mul_f32 v11, v11, v119
    v_rcp_f32 v121, v121
    v_mfma_f32_32x32x16_bf16 v[56:71], a[148:151], v[76:79], v[56:71]
    buffer_load_dwordx4 a[228:231], v152, s[56:59], s19 offen offset:2048 sc1
    ds_read_b128 v[76:79], v126 offset:29696
    s_waitcnt lgkmcnt(5)
    v_mfma_f32_32x32x16_bf16 v[40:55], a[40:43], v[80:83], v[40:55]
    v_mul_f32 v12, v12, v120
    v_rcp_f32 v122, v122
    v_mul_f32 v13, v13, v121
    v_rcp_f32 v123, v123
    v_mfma_f32_32x32x16_bf16 v[56:71], a[152:155], v[80:83], v[56:71]
    v_mul_f32 v14, v14, v122
    ds_read_b128 v[80:83], v126 offset:30720
    s_waitcnt lgkmcnt(5)
    v_mfma_f32_32x32x16_bf16 v[40:55], a[44:47], v[84:87], v[40:55]
    v_cvt_pk_bf16_f32 v16, v8, v9
    v_cvt_pk_bf16_f32 v17, v10, v11
    v_cvt_pk_bf16_f32 v18, v12, v13
    v_mul_f32 v15, v15, v123
    v_cvt_pk_bf16_f32 v19, v14, v15
    v_mfma_f32_32x32x16_bf16 v[56:71], a[156:159], v[84:87], v[56:71]
    buffer_load_dwordx4 a[232:235], v154, s[56:59], s19 offen offset:2048 sc1
    ds_read_b128 v[84:87], v126 offset:31744
    s_waitcnt lgkmcnt(5)
    v_mfma_f32_32x32x16_bf16 v[40:55], a[48:51], v[88:91], v[40:55]
    buffer_store_dwordx4 v[16:19], v240, s[56:59], s11 offen offset:0 sc1
    v_mul_f32 v116, v108, v24
    v_mul_f32 v117, v108, v25
    v_mfma_f32_32x32x16_bf16 v[56:71], a[160:163], v[88:91], v[56:71]
    buffer_load_dwordx4 a[236:239], v152, s[56:59], s19 offen offset:3072 sc1
    ds_read_b128 v[88:91], v126 offset:32768
    s_waitcnt lgkmcnt(5)
    v_mfma_f32_32x32x16_bf16 v[40:55], a[52:55], v[92:95], v[40:55]
    v_mul_f32 v118, v108, v26
    v_mul_f32 v119, v108, v27
    v_mul_f32 v120, v108, v28
    v_mul_f32 v121, v108, v29
    v_mul_f32 v122, v108, v30
    v_mul_f32 v123, v108, v31
    v_mfma_f32_32x32x16_bf16 v[56:71], a[164:167], v[92:95], v[56:71]
    v_exp_f32 v116, v116
    ds_read_b128 v[92:95], v126 offset:33792
    s_waitcnt lgkmcnt(5)
    v_mfma_f32_32x32x16_bf16 v[40:55], a[56:59], v[72:75], v[40:55]
    v_mul_f32 v24, v24, v32
    v_exp_f32 v117, v117
    v_mul_f32 v25, v25, v33
    v_exp_f32 v118, v118
    v_mfma_f32_32x32x16_bf16 v[56:71], a[168:171], v[72:75], v[56:71]
    buffer_load_dwordx4 a[240:243], v154, s[56:59], s19 offen offset:3072 sc1
    ds_read_b128 v[72:75], v126 offset:34816
    s_waitcnt lgkmcnt(5)
    v_mfma_f32_32x32x16_bf16 v[40:55], a[60:63], v[76:79], v[40:55]
    v_mul_f32 v26, v26, v34
    v_exp_f32 v119, v119
    v_mul_f32 v27, v27, v35
    v_exp_f32 v120, v120
    v_mfma_f32_32x32x16_bf16 v[56:71], a[172:175], v[76:79], v[56:71]
    v_mul_f32 v28, v28, v36
    ds_read_b128 v[76:79], v127 offset:28672
    s_waitcnt lgkmcnt(5)
    v_mfma_f32_32x32x16_bf16 v[40:55], a[64:67], v[80:83], v[40:55]
    v_exp_f32 v121, v121
    v_mul_f32 v29, v29, v37
    v_exp_f32 v122, v122
    v_mul_f32 v30, v30, v38
    v_mfma_f32_32x32x16_bf16 v[56:71], a[176:179], v[80:83], v[56:71]
    buffer_load_dwordx4 a[244:247], v153, s[56:59], s19 offen offset:0 sc1
    ds_read_b128 v[80:83], v127 offset:29696
    s_waitcnt lgkmcnt(5)
    v_mfma_f32_32x32x16_bf16 v[40:55], a[68:71], v[84:87], v[40:55]
    v_exp_f32 v123, v123
    v_mul_f32 v31, v31, v39
    v_fma_f32 v116, v116, v109, v109
    v_fma_f32 v117, v117, v109, v109
    v_mfma_f32_32x32x16_bf16 v[56:71], a[180:183], v[84:87], v[56:71]
    buffer_load_dwordx4 a[248:251], v155, s[56:59], s19 offen offset:0 sc1
    ds_read_b128 v[84:87], v127 offset:30720
    s_waitcnt lgkmcnt(5)
    v_mfma_f32_32x32x16_bf16 v[40:55], a[72:75], v[88:91], v[40:55]
    v_fma_f32 v118, v118, v109, v109
    v_fma_f32 v119, v119, v109, v109
    v_fma_f32 v120, v120, v109, v109
    v_fma_f32 v121, v121, v109, v109
    v_mfma_f32_32x32x16_bf16 v[56:71], a[184:187], v[88:91], v[56:71]
    v_fma_f32 v122, v122, v109, v109
    ds_read_b128 v[88:91], v127 offset:31744
    s_waitcnt lgkmcnt(5)
    v_mfma_f32_32x32x16_bf16 v[40:55], a[76:79], v[92:95], v[40:55]
    v_fma_f32 v123, v123, v109, v109
    v_rcp_f32 v116, v116
    v_rcp_f32 v117, v117
    v_mfma_f32_32x32x16_bf16 v[56:71], a[188:191], v[92:95], v[56:71]
    buffer_load_dwordx4 a[252:255], v153, s[56:59], s19 offen offset:1024 sc1
    ds_read_b128 v[92:95], v127 offset:32768
    s_waitcnt lgkmcnt(5)
    v_mfma_f32_32x32x16_bf16 v[40:55], a[80:83], v[72:75], v[40:55]
    v_mul_f32 v24, v24, v116
    v_rcp_f32 v118, v118
    v_mul_f32 v25, v25, v117
    v_rcp_f32 v119, v119
    v_mfma_f32_32x32x16_bf16 v[56:71], a[192:195], v[72:75], v[56:71]
    v_mul_f32 v26, v26, v118
    ds_read_b128 v[72:75], v127 offset:33792
    s_waitcnt lgkmcnt(5)
    v_mfma_f32_32x32x16_bf16 v[40:55], a[84:87], v[76:79], v[40:55]
    v_rcp_f32 v120, v120
    v_mul_f32 v27, v27, v119
    v_rcp_f32 v121, v121
    v_mul_f32 v28, v28, v120
    v_mfma_f32_32x32x16_bf16 v[56:71], a[196:199], v[76:79], v[56:71]
    buffer_load_dwordx4 v[156:159], v155, s[56:59], s19 offen offset:1024 sc1
    ds_read_b128 v[76:79], v127 offset:34816
    s_waitcnt lgkmcnt(5)
    v_mfma_f32_32x32x16_bf16 v[40:55], a[88:91], v[80:83], v[40:55]
    v_rcp_f32 v122, v122
    v_mul_f32 v29, v29, v121
    v_rcp_f32 v123, v123
    v_mul_f32 v30, v30, v122
    v_mfma_f32_32x32x16_bf16 v[56:71], a[200:203], v[80:83], v[56:71]
    buffer_load_dwordx4 v[160:163], v153, s[56:59], s19 offen offset:2048 sc1
    s_waitcnt vmcnt(21)
    s_barrier
    ds_read_b128 v[80:83], v128 offset:0
    s_waitcnt lgkmcnt(5)
    v_mfma_f32_32x32x16_bf16 v[40:55], a[92:95], v[84:87], v[40:55]
    v_cvt_pk_bf16_f32 v32, v24, v25
    v_cvt_pk_bf16_f32 v33, v26, v27
    v_cvt_pk_bf16_f32 v34, v28, v29
    v_mul_f32 v31, v31, v123
    v_cvt_pk_bf16_f32 v35, v30, v31
    v_mfma_f32_32x32x16_bf16 v[56:71], a[204:207], v[84:87], v[56:71]
    ds_read_b128 v[84:87], v128 offset:1024
    s_waitcnt lgkmcnt(5)
    v_mfma_f32_32x32x16_bf16 v[40:55], a[96:99], v[88:91], v[40:55]
    buffer_store_dwordx4 v[32:35], v240, s[56:59], s11 offen offset:1024 sc1
    v_mfma_f32_32x32x16_bf16 v[56:71], a[208:211], v[88:91], v[56:71]
    buffer_load_dwordx4 v[164:167], v155, s[56:59], s19 offen offset:2048 sc1
    ds_read_b128 v[88:91], v128 offset:2048
    s_waitcnt lgkmcnt(5)
    v_mfma_f32_32x32x16_bf16 v[40:55], a[100:103], v[92:95], v[40:55]
    v_mfma_f32_32x32x16_bf16 v[56:71], a[212:215], v[92:95], v[56:71]
    ds_read_b128 v[92:95], v128 offset:3072
    s_waitcnt lgkmcnt(5)
    v_mfma_f32_32x32x16_bf16 v[40:55], a[104:107], v[72:75], v[40:55]
    v_mfma_f32_32x32x16_bf16 v[56:71], a[216:219], v[72:75], v[56:71]
    buffer_load_dwordx4 v[168:171], v152, s[56:59], s20 offen offset:0 sc1
    ds_read_b128 v[72:75], v128 offset:4096
    s_waitcnt lgkmcnt(5)
    v_mfma_f32_32x32x16_bf16 v[40:55], a[108:111], v[76:79], v[40:55]
    v_mfma_f32_32x32x16_bf16 v[56:71], a[220:223], v[76:79], v[56:71]
    buffer_load_dwordx4 v[172:175], v154, s[56:59], s20 offen offset:0 sc1
    s_waitcnt lgkmcnt(15)
    v_mfma_f32_32x32x16_bf16 v[40:55], v[132:135], v[98:101], v[40:55]
    v_mfma_f32_32x32x16_bf16 v[56:71], v[136:139], v[98:101], v[56:71]
    ds_read_b128 v[76:79], v128 offset:5120
    s_waitcnt lgkmcnt(5)
    v_mfma_f32_32x32x16_bf16 v[8:23], a[0:3], v[80:83], 0
    v_mfma_f32_32x32x16_bf16 v[24:39], a[112:115], v[80:83], 0
    ds_read_b128 v[80:83], v128 offset:6144
    s_waitcnt lgkmcnt(5)
    v_mfma_f32_32x32x16_bf16 v[8:23], a[4:7], v[84:87], v[8:23]
    s_nop 3
    v_mul_f32 v116, v110, v40
    v_mul_f32 v117, v110, v41
    v_mul_f32 v118, v110, v42
    v_mul_f32 v119, v110, v43
    v_mul_f32 v120, v110, v44
    v_mul_f32 v121, v110, v45
    v_mfma_f32_32x32x16_bf16 v[24:39], a[116:119], v[84:87], v[24:39]
    buffer_load_dwordx4 v[176:179], v152, s[56:59], s20 offen offset:1024 sc1
    ds_read_b128 v[84:87], v129 offset:0
    s_waitcnt lgkmcnt(5)
    v_mfma_f32_32x32x16_bf16 v[8:23], a[8:11], v[88:91], v[8:23]
    v_mul_f32 v122, v110, v46
    v_mul_f32 v123, v110, v47
    v_exp_f32 v116, v116
    v_mul_f32 v40, v40, v48
    v_mfma_f32_32x32x16_bf16 v[24:39], a[120:123], v[88:91], v[24:39]
    v_exp_f32 v117, v117
    ds_read_b128 v[88:91], v129 offset:1024
    s_waitcnt lgkmcnt(5)
    v_mfma_f32_32x32x16_bf16 v[8:23], a[12:15], v[92:95], v[8:23]
    v_mul_f32 v41, v41, v49
    v_exp_f32 v118, v118
    v_mul_f32 v42, v42, v50
    v_exp_f32 v119, v119
    v_mfma_f32_32x32x16_bf16 v[24:39], a[124:127], v[92:95], v[24:39]
    buffer_load_dwordx4 v[180:183], v154, s[56:59], s20 offen offset:1024 sc1
    ds_read_b128 v[92:95], v129 offset:2048
    s_waitcnt lgkmcnt(5)
    v_mfma_f32_32x32x16_bf16 v[8:23], a[16:19], v[72:75], v[8:23]
    v_mul_f32 v43, v43, v51
    v_exp_f32 v120, v120
    v_mul_f32 v44, v44, v52
    v_exp_f32 v121, v121
    v_mfma_f32_32x32x16_bf16 v[24:39], a[128:131], v[72:75], v[24:39]
    buffer_load_dwordx4 v[184:187], v152, s[56:59], s20 offen offset:2048 sc1
    ds_read_b128 v[72:75], v129 offset:3072
    s_waitcnt lgkmcnt(5)
    v_mfma_f32_32x32x16_bf16 v[8:23], a[20:23], v[76:79], v[8:23]
    v_mul_f32 v45, v45, v53
    v_exp_f32 v122, v122
    v_mul_f32 v46, v46, v54
    v_exp_f32 v123, v123
    v_mfma_f32_32x32x16_bf16 v[24:39], a[132:135], v[76:79], v[24:39]
    v_mul_f32 v47, v47, v55
    ds_read_b128 v[76:79], v129 offset:4096
    s_waitcnt lgkmcnt(5)
    v_mfma_f32_32x32x16_bf16 v[8:23], a[24:27], v[80:83], v[8:23]
    v_fma_f32 v116, v116, v111, v111
    v_fma_f32 v117, v117, v111, v111
    v_fma_f32 v118, v118, v111, v111
    v_fma_f32 v119, v119, v111, v111
    v_mfma_f32_32x32x16_bf16 v[24:39], a[136:139], v[80:83], v[24:39]
    buffer_load_dwordx4 v[188:191], v154, s[56:59], s20 offen offset:2048 sc1
    ds_read_b128 v[80:83], v129 offset:5120
    s_waitcnt lgkmcnt(5)
    v_mfma_f32_32x32x16_bf16 v[8:23], a[28:31], v[84:87], v[8:23]
    v_fma_f32 v120, v120, v111, v111
    v_fma_f32 v121, v121, v111, v111
    v_fma_f32 v122, v122, v111, v111
    v_fma_f32 v123, v123, v111, v111
    v_mfma_f32_32x32x16_bf16 v[24:39], a[140:143], v[84:87], v[24:39]
    v_rcp_f32 v116, v116
    ds_read_b128 v[84:87], v129 offset:6144
    s_waitcnt lgkmcnt(5)
    v_mfma_f32_32x32x16_bf16 v[8:23], a[32:35], v[88:91], v[8:23]
    v_rcp_f32 v117, v117
    v_mul_f32 v40, v40, v116
    v_rcp_f32 v118, v118
    v_mul_f32 v41, v41, v117
    v_mfma_f32_32x32x16_bf16 v[24:39], a[144:147], v[88:91], v[24:39]
    buffer_load_dwordx4 v[192:195], v152, s[56:59], s20 offen offset:3072 sc1
    ds_read_b128 v[88:91], v130 offset:0
    s_waitcnt lgkmcnt(5)
    v_mfma_f32_32x32x16_bf16 v[8:23], a[36:39], v[92:95], v[8:23]
    v_rcp_f32 v119, v119
    v_mul_f32 v42, v42, v118
    v_rcp_f32 v120, v120
    v_mul_f32 v43, v43, v119
    v_mfma_f32_32x32x16_bf16 v[24:39], a[148:151], v[92:95], v[24:39]
    buffer_load_dwordx4 v[196:199], v154, s[56:59], s20 offen offset:3072 sc1
    ds_read_b128 v[92:95], v130 offset:1024
    s_waitcnt lgkmcnt(5)
    v_mfma_f32_32x32x16_bf16 v[8:23], a[40:43], v[72:75], v[8:23]
    v_rcp_f32 v121, v121
    v_mul_f32 v44, v44, v120
    v_rcp_f32 v122, v122
    v_mfma_f32_32x32x16_bf16 v[24:39], a[152:155], v[72:75], v[24:39]
    v_mul_f32 v45, v45, v121
    ds_read_b128 v[72:75], v130 offset:2048
    s_waitcnt lgkmcnt(5)
    v_mfma_f32_32x32x16_bf16 v[8:23], a[44:47], v[76:79], v[8:23]
    v_rcp_f32 v123, v123
    v_mul_f32 v46, v46, v122
    v_cvt_pk_bf16_f32 v48, v40, v41
    v_cvt_pk_bf16_f32 v49, v42, v43
    v_mfma_f32_32x32x16_bf16 v[24:39], a[156:159], v[76:79], v[24:39]
    buffer_load_dwordx4 v[200:203], v153, s[56:59], s20 offen offset:0 sc1
    ds_read_b128 v[76:79], v130 offset:3072
    s_waitcnt lgkmcnt(5)
    v_mfma_f32_32x32x16_bf16 v[8:23], a[48:51], v[80:83], v[8:23]
    v_cvt_pk_bf16_f32 v50, v44, v45
    v_mul_f32 v47, v47, v123
    v_cvt_pk_bf16_f32 v51, v46, v47
    v_mfma_f32_32x32x16_bf16 v[24:39], a[160:163], v[80:83], v[24:39]
    ds_read_b128 v[80:83], v130 offset:4096
    s_waitcnt lgkmcnt(5)
    v_mfma_f32_32x32x16_bf16 v[8:23], a[52:55], v[84:87], v[8:23]
    buffer_store_dwordx4 v[48:51], v240, s[56:59], s12 offen offset:0 sc1
    v_mul_f32 v116, v110, v56
    v_mul_f32 v117, v110, v57
    v_mfma_f32_32x32x16_bf16 v[24:39], a[164:167], v[84:87], v[24:39]
    buffer_load_dwordx4 v[204:207], v155, s[56:59], s20 offen offset:0 sc1
    ds_read_b128 v[84:87], v130 offset:5120
    s_waitcnt lgkmcnt(5)
    v_mfma_f32_32x32x16_bf16 v[8:23], a[56:59], v[88:91], v[8:23]
    v_mul_f32 v118, v110, v58
    v_mul_f32 v119, v110, v59
    v_mul_f32 v120, v110, v60
    v_mul_f32 v121, v110, v61
    v_mul_f32 v122, v110, v62
    v_mul_f32 v123, v110, v63
    v_mfma_f32_32x32x16_bf16 v[24:39], a[168:171], v[88:91], v[24:39]
    buffer_load_dwordx4 v[208:211], v153, s[56:59], s20 offen offset:1024 sc1
    ds_read_b128 v[88:91], v130 offset:6144
    s_waitcnt lgkmcnt(5)
    v_mfma_f32_32x32x16_bf16 v[8:23], a[60:63], v[92:95], v[8:23]
    v_exp_f32 v116, v116
    v_mul_f32 v56, v56, v64
    v_exp_f32 v117, v117
    v_mul_f32 v57, v57, v65
    v_mfma_f32_32x32x16_bf16 v[24:39], a[172:175], v[92:95], v[24:39]
    v_exp_f32 v118, v118
    ds_read_b128 v[92:95], v131 offset:0
    s_waitcnt lgkmcnt(5)
    v_mfma_f32_32x32x16_bf16 v[8:23], a[64:67], v[72:75], v[8:23]
    v_mul_f32 v58, v58, v66
    v_exp_f32 v119, v119
    v_mul_f32 v59, v59, v67
    v_exp_f32 v120, v120
    v_mfma_f32_32x32x16_bf16 v[24:39], a[176:179], v[72:75], v[24:39]
    buffer_load_dwordx4 v[212:215], v155, s[56:59], s20 offen offset:1024 sc1
    ds_read_b128 v[72:75], v131 offset:1024
    s_waitcnt lgkmcnt(5)
    v_mfma_f32_32x32x16_bf16 v[8:23], a[68:71], v[76:79], v[8:23]
    v_mul_f32 v60, v60, v68
    v_exp_f32 v121, v121
    v_mul_f32 v61, v61, v69
    v_mfma_f32_32x32x16_bf16 v[24:39], a[180:183], v[76:79], v[24:39]
    v_exp_f32 v122, v122
    ds_read_b128 v[76:79], v131 offset:2048
    s_waitcnt lgkmcnt(5)
    v_mfma_f32_32x32x16_bf16 v[8:23], a[72:75], v[80:83], v[8:23]
    v_mul_f32 v62, v62, v70
    v_exp_f32 v123, v123
    v_mul_f32 v63, v63, v71
    v_fma_f32 v116, v116, v111, v111
    v_mfma_f32_32x32x16_bf16 v[24:39], a[184:187], v[80:83], v[24:39]
    buffer_load_dwordx4 v[216:219], v153, s[56:59], s20 offen offset:2048 sc1
    ds_read_b128 v[80:83], v131 offset:3072
    s_waitcnt lgkmcnt(5)
    v_mfma_f32_32x32x16_bf16 v[8:23], a[76:79], v[84:87], v[8:23]
    v_fma_f32 v117, v117, v111, v111
    v_fma_f32 v118, v118, v111, v111
    v_fma_f32 v119, v119, v111, v111
    v_fma_f32 v120, v120, v111, v111
    v_mfma_f32_32x32x16_bf16 v[24:39], a[188:191], v[84:87], v[24:39]
    buffer_load_dwordx4 v[220:223], v155, s[56:59], s20 offen offset:2048 sc1
    ds_read_b128 v[84:87], v131 offset:4096
    s_waitcnt lgkmcnt(5)
    v_mfma_f32_32x32x16_bf16 v[8:23], a[80:83], v[88:91], v[8:23]
    v_fma_f32 v121, v121, v111, v111
    v_fma_f32 v122, v122, v111, v111
    v_fma_f32 v123, v123, v111, v111
    v_rcp_f32 v116, v116
    v_mfma_f32_32x32x16_bf16 v[24:39], a[192:195], v[88:91], v[24:39]
    v_rcp_f32 v117, v117
    ds_read_b128 v[88:91], v131 offset:5120
    s_waitcnt lgkmcnt(5)
    v_mfma_f32_32x32x16_bf16 v[8:23], a[84:87], v[92:95], v[8:23]
    v_mul_f32 v56, v56, v116
    v_rcp_f32 v118, v118
    v_mul_f32 v57, v57, v117
    v_rcp_f32 v119, v119
    v_mfma_f32_32x32x16_bf16 v[24:39], a[196:199], v[92:95], v[24:39]
    buffer_load_dwordx4 v[224:227], v152, s[56:59], s21 offen offset:0 sc1
    ds_read_b128 v[92:95], v131 offset:6144
    s_waitcnt lgkmcnt(5)
    v_mfma_f32_32x32x16_bf16 v[8:23], a[88:91], v[72:75], v[8:23]
    v_mul_f32 v58, v58, v118
    v_rcp_f32 v120, v120
    v_mul_f32 v59, v59, v119
    v_rcp_f32 v121, v121
    v_mfma_f32_32x32x16_bf16 v[24:39], a[200:203], v[72:75], v[24:39]
    v_mul_f32 v60, v60, v120
    s_waitcnt vmcnt(32)
    s_barrier
    ds_read_b128 v[72:75], v128 offset:28672
    s_waitcnt lgkmcnt(5)
    v_mfma_f32_32x32x16_bf16 v[8:23], a[92:95], v[76:79], v[8:23]
    v_rcp_f32 v122, v122
    v_mul_f32 v61, v61, v121
    v_rcp_f32 v123, v123
    v_mul_f32 v62, v62, v122
    v_mfma_f32_32x32x16_bf16 v[24:39], a[204:207], v[76:79], v[24:39]
    buffer_load_dwordx4 v[228:231], v154, s[56:59], s21 offen offset:0 sc1
    ds_read_b128 v[76:79], v128 offset:29696
    s_waitcnt lgkmcnt(5)
    v_mfma_f32_32x32x16_bf16 v[8:23], a[96:99], v[80:83], v[8:23]
    v_cvt_pk_bf16_f32 v64, v56, v57
    v_cvt_pk_bf16_f32 v65, v58, v59
    v_cvt_pk_bf16_f32 v66, v60, v61
    v_mul_f32 v63, v63, v123
    v_cvt_pk_bf16_f32 v67, v62, v63
    v_mfma_f32_32x32x16_bf16 v[24:39], a[208:211], v[80:83], v[24:39]
    ds_read_b128 v[80:83], v128 offset:30720
    s_waitcnt lgkmcnt(5)
    v_mfma_f32_32x32x16_bf16 v[8:23], a[100:103], v[84:87], v[8:23]
    buffer_store_dwordx4 v[64:67], v240, s[56:59], s12 offen offset:1024 sc1
    v_mfma_f32_32x32x16_bf16 v[24:39], a[212:215], v[84:87], v[24:39]
    ds_read_b128 v[84:87], v128 offset:31744
    s_waitcnt lgkmcnt(5)
    v_mfma_f32_32x32x16_bf16 v[8:23], a[104:107], v[88:91], v[8:23]
    v_mfma_f32_32x32x16_bf16 v[24:39], a[216:219], v[88:91], v[24:39]
    ds_read_b128 v[88:91], v128 offset:32768
    s_waitcnt lgkmcnt(5)
    v_mfma_f32_32x32x16_bf16 v[8:23], a[108:111], v[92:95], v[8:23]
    v_mfma_f32_32x32x16_bf16 v[24:39], a[220:223], v[92:95], v[24:39]
    s_waitcnt lgkmcnt(15)
    v_mfma_f32_32x32x16_bf16 v[8:23], v[132:135], v[100:103], v[8:23]
    v_mfma_f32_32x32x16_bf16 v[24:39], v[136:139], v[100:103], v[24:39]
    ds_read_b128 v[92:95], v128 offset:33792
    s_waitcnt lgkmcnt(5)
    v_mfma_f32_32x32x16_bf16 v[40:55], a[0:3], v[72:75], 0
    v_mfma_f32_32x32x16_bf16 v[56:71], a[112:115], v[72:75], 0
    ds_read_b128 v[72:75], v128 offset:34816
    s_waitcnt lgkmcnt(5)
    v_mfma_f32_32x32x16_bf16 v[40:55], a[4:7], v[76:79], v[40:55]
    s_nop 3
    v_mul_f32 v116, v112, v8
    v_mul_f32 v117, v112, v9
    v_mul_f32 v118, v112, v10
    v_mul_f32 v119, v112, v11
    v_mul_f32 v120, v112, v12
    v_mul_f32 v121, v112, v13
    v_mfma_f32_32x32x16_bf16 v[56:71], a[116:119], v[76:79], v[56:71]
    buffer_load_dwordx4 a[0:3], v152, s[56:59], s21 offen offset:1024 sc1
    ds_read_b128 v[76:79], v129 offset:28672
    s_waitcnt lgkmcnt(5)
    v_mfma_f32_32x32x16_bf16 v[40:55], a[8:11], v[80:83], v[40:55]
    v_mul_f32 v122, v112, v14
    v_mul_f32 v123, v112, v15
    v_exp_f32 v116, v116
    v_mul_f32 v8, v8, v16
    v_mfma_f32_32x32x16_bf16 v[56:71], a[120:123], v[80:83], v[56:71]
    buffer_load_dwordx4 a[4:7], v154, s[56:59], s21 offen offset:1024 sc1
    ds_read_b128 v[80:83], v129 offset:29696
    s_waitcnt lgkmcnt(5)
    v_mfma_f32_32x32x16_bf16 v[40:55], a[12:15], v[84:87], v[40:55]
    v_exp_f32 v117, v117
    v_mul_f32 v9, v9, v17
    v_exp_f32 v118, v118
    v_mul_f32 v10, v10, v18
    v_mfma_f32_32x32x16_bf16 v[56:71], a[124:127], v[84:87], v[56:71]
    buffer_load_dwordx4 a[8:11], v152, s[56:59], s21 offen offset:2048 sc1
    ds_read_b128 v[84:87], v129 offset:30720
    s_waitcnt lgkmcnt(5)
    v_mfma_f32_32x32x16_bf16 v[40:55], a[16:19], v[88:91], v[40:55]
    v_exp_f32 v119, v119
    v_mul_f32 v11, v11, v19
    v_exp_f32 v120, v120
    v_mul_f32 v12, v12, v20
    v_mfma_f32_32x32x16_bf16 v[56:71], a[128:131], v[88:91], v[56:71]
    buffer_load_dwordx4 a[12:15], v154, s[56:59], s21 offen offset:2048 sc1
    ds_read_b128 v[88:91], v129 offset:31744
    s_waitcnt lgkmcnt(5)
    v_mfma_f32_32x32x16_bf16 v[40:55], a[20:23], v[92:95], v[40:55]
    v_exp_f32 v121, v121
    v_mul_f32 v13, v13, v21
    v_exp_f32 v122, v122
    v_mul_f32 v14, v14, v22
    v_mfma_f32_32x32x16_bf16 v[56:71], a[132:135], v[92:95], v[56:71]
    buffer_load_dwordx4 a[16:19], v152, s[56:59], s21 offen offset:3072 sc1
    ds_read_b128 v[92:95], v129 offset:32768
    s_waitcnt lgkmcnt(5)
    v_mfma_f32_32x32x16_bf16 v[40:55], a[24:27], v[72:75], v[40:55]
    v_exp_f32 v123, v123
    v_mul_f32 v15, v15, v23
    v_fma_f32 v116, v116, v113, v113
    v_fma_f32 v117, v117, v113, v113
    v_mfma_f32_32x32x16_bf16 v[56:71], a[136:139], v[72:75], v[56:71]
    buffer_load_dwordx4 a[20:23], v154, s[56:59], s21 offen offset:3072 sc1
    s_lshl_b32 s83, s74, 8
    s_add_u32 s83, s83, 2236416
    s_waitcnt vmcnt(6)
    s_barrier
    v_mov_b32 v2, 1
    v_mov_b32 v3, 0
    s_mov_b64 exec, 1
    buffer_atomic_add v2, v3, s[60:63], s83 offen sc1
    s_mov_b64 exec, -1
    ds_read_b128 v[72:75], v129 offset:33792
    s_waitcnt lgkmcnt(5)
    v_mfma_f32_32x32x16_bf16 v[40:55], a[28:31], v[76:79], v[40:55]
    v_fma_f32 v118, v118, v113, v113
    v_fma_f32 v119, v119, v113, v113
    v_fma_f32 v120, v120, v113, v113
    v_fma_f32 v121, v121, v113, v113
    v_mfma_f32_32x32x16_bf16 v[56:71], a[140:143], v[76:79], v[56:71]
    buffer_load_dwordx4 a[24:27], v153, s[56:59], s21 offen offset:0 sc1
    ds_read_b128 v[76:79], v129 offset:34816
    s_waitcnt lgkmcnt(5)
    v_mfma_f32_32x32x16_bf16 v[40:55], a[32:35], v[80:83], v[40:55]
    v_fma_f32 v122, v122, v113, v113
    v_fma_f32 v123, v123, v113, v113
    v_rcp_f32 v116, v116
    v_mfma_f32_32x32x16_bf16 v[56:71], a[144:147], v[80:83], v[56:71]
    buffer_load_dwordx4 a[28:31], v155, s[56:59], s21 offen offset:0 sc1
    ds_read_b128 v[80:83], v130 offset:28672
    s_waitcnt lgkmcnt(5)
    v_mfma_f32_32x32x16_bf16 v[40:55], a[36:39], v[84:87], v[40:55]
    v_rcp_f32 v117, v117
    v_mul_f32 v8, v8, v116
    v_rcp_f32 v118, v118
    v_mul_f32 v9, v9, v117
    v_mfma_f32_32x32x16_bf16 v[56:71], a[148:151], v[84:87], v[56:71]
    buffer_load_dwordx4 a[32:35], v153, s[56:59], s21 offen offset:1024 sc1
    ds_read_b128 v[84:87], v130 offset:29696
    s_waitcnt lgkmcnt(5)
    v_mfma_f32_32x32x16_bf16 v[40:55], a[40:43], v[88:91], v[40:55]
    v_rcp_f32 v119, v119
    v_mul_f32 v10, v10, v118
    v_rcp_f32 v120, v120
    v_mul_f32 v11, v11, v119
    v_mfma_f32_32x32x16_bf16 v[56:71], a[152:155], v[88:91], v[56:71]
    buffer_load_dwordx4 a[36:39], v155, s[56:59], s21 offen offset:1024 sc1
    ds_read_b128 v[88:91], v130 offset:30720
    s_waitcnt lgkmcnt(5)
    v_mfma_f32_32x32x16_bf16 v[40:55], a[44:47], v[92:95], v[40:55]
    v_rcp_f32 v121, v121
    v_mul_f32 v12, v12, v120
    v_rcp_f32 v122, v122
    v_mul_f32 v13, v13, v121
    v_mfma_f32_32x32x16_bf16 v[56:71], a[156:159], v[92:95], v[56:71]
    buffer_load_dwordx4 a[40:43], v153, s[56:59], s21 offen offset:2048 sc1
    ds_read_b128 v[92:95], v130 offset:31744
    s_waitcnt lgkmcnt(5)
    v_mfma_f32_32x32x16_bf16 v[40:55], a[48:51], v[72:75], v[40:55]
    v_rcp_f32 v123, v123
    v_mul_f32 v14, v14, v122
    v_cvt_pk_bf16_f32 v16, v8, v9
    v_cvt_pk_bf16_f32 v17, v10, v11
    v_mfma_f32_32x32x16_bf16 v[56:71], a[160:163], v[72:75], v[56:71]
    buffer_load_dwordx4 a[44:47], v155, s[56:59], s21 offen offset:2048 sc1
    ds_read_b128 v[72:75], v130 offset:32768
    s_waitcnt lgkmcnt(5)
    v_mfma_f32_32x32x16_bf16 v[40:55], a[52:55], v[76:79], v[40:55]
    v_cvt_pk_bf16_f32 v18, v12, v13
    v_mul_f32 v15, v15, v123
    v_cvt_pk_bf16_f32 v19, v14, v15
    v_mfma_f32_32x32x16_bf16 v[56:71], a[164:167], v[76:79], v[56:71]
    buffer_load_dwordx4 a[48:51], v152, s[56:59], s22 offen offset:0 sc1
    ds_read_b128 v[76:79], v130 offset:33792
    s_waitcnt lgkmcnt(5)
    v_mfma_f32_32x32x16_bf16 v[40:55], a[56:59], v[80:83], v[40:55]
    buffer_store_dwordx4 v[16:19], v240, s[56:59], s13 offen offset:0 sc1
    v_mul_f32 v116, v112, v24
    v_mul_f32 v117, v112, v25
    v_mfma_f32_32x32x16_bf16 v[56:71], a[168:171], v[80:83], v[56:71]
    buffer_load_dwordx4 a[52:55], v154, s[56:59], s22 offen offset:0 sc1
    ds_read_b128 v[80:83], v130 offset:34816
    s_waitcnt lgkmcnt(5)
    v_mfma_f32_32x32x16_bf16 v[40:55], a[60:63], v[84:87], v[40:55]
    v_mul_f32 v118, v112, v26
    v_mul_f32 v119, v112, v27
    v_mul_f32 v120, v112, v28
    v_mul_f32 v121, v112, v29
    v_mul_f32 v122, v112, v30
    v_mul_f32 v123, v112, v31
    v_mfma_f32_32x32x16_bf16 v[56:71], a[172:175], v[84:87], v[56:71]
    buffer_load_dwordx4 a[56:59], v152, s[56:59], s22 offen offset:1024 sc1
    ds_read_b128 v[84:87], v131 offset:28672
    s_waitcnt lgkmcnt(5)
    v_mfma_f32_32x32x16_bf16 v[40:55], a[64:67], v[88:91], v[40:55]
    v_exp_f32 v116, v116
    v_mul_f32 v24, v24, v32
    v_exp_f32 v117, v117
    v_mul_f32 v25, v25, v33
    v_mfma_f32_32x32x16_bf16 v[56:71], a[176:179], v[88:91], v[56:71]
    buffer_load_dwordx4 a[60:63], v154, s[56:59], s22 offen offset:1024 sc1
    ds_read_b128 v[88:91], v131 offset:29696
    s_waitcnt lgkmcnt(5)
    v_mfma_f32_32x32x16_bf16 v[40:55], a[68:71], v[92:95], v[40:55]
    v_exp_f32 v118, v118
    v_mul_f32 v26, v26, v34
    v_exp_f32 v119, v119
    v_mul_f32 v27, v27, v35
    v_mfma_f32_32x32x16_bf16 v[56:71], a[180:183], v[92:95], v[56:71]
    buffer_load_dwordx4 a[64:67], v152, s[56:59], s22 offen offset:2048 sc1
    ds_read_b128 v[92:95], v131 offset:30720
    s_waitcnt lgkmcnt(5)
    v_mfma_f32_32x32x16_bf16 v[40:55], a[72:75], v[72:75], v[40:55]
    v_exp_f32 v120, v120
    v_mul_f32 v28, v28, v36
    v_exp_f32 v121, v121
    v_mul_f32 v29, v29, v37
    v_mfma_f32_32x32x16_bf16 v[56:71], a[184:187], v[72:75], v[56:71]
    buffer_load_dwordx4 a[68:71], v154, s[56:59], s22 offen offset:2048 sc1
    ds_read_b128 v[72:75], v131 offset:31744
    s_waitcnt lgkmcnt(5)
    v_mfma_f32_32x32x16_bf16 v[40:55], a[76:79], v[76:79], v[40:55]
    v_exp_f32 v122, v122
    v_mul_f32 v30, v30, v38
    v_exp_f32 v123, v123
    v_mfma_f32_32x32x16_bf16 v[56:71], a[188:191], v[76:79], v[56:71]
    buffer_load_dwordx4 a[72:75], v152, s[56:59], s22 offen offset:3072 sc1
    ds_read_b128 v[76:79], v131 offset:32768
    s_waitcnt lgkmcnt(5)
    v_mfma_f32_32x32x16_bf16 v[40:55], a[80:83], v[80:83], v[40:55]
    v_mul_f32 v31, v31, v39
    v_fma_f32 v116, v116, v113, v113
    v_fma_f32 v117, v117, v113, v113
    v_fma_f32 v118, v118, v113, v113
    v_fma_f32 v119, v119, v113, v113
    v_mfma_f32_32x32x16_bf16 v[56:71], a[192:195], v[80:83], v[56:71]
    buffer_load_dwordx4 a[76:79], v154, s[56:59], s22 offen offset:3072 sc1
    ds_read_b128 v[80:83], v131 offset:33792
    s_waitcnt lgkmcnt(5)
    v_mfma_f32_32x32x16_bf16 v[40:55], a[84:87], v[84:87], v[40:55]
    v_fma_f32 v120, v120, v113, v113
    v_fma_f32 v121, v121, v113, v113
    v_fma_f32 v122, v122, v113, v113
    v_fma_f32 v123, v123, v113, v113
    v_mfma_f32_32x32x16_bf16 v[56:71], a[196:199], v[84:87], v[56:71]
    buffer_load_dwordx4 a[80:83], v153, s[56:59], s22 offen offset:0 sc1
    ds_read_b128 v[84:87], v131 offset:34816
    s_waitcnt lgkmcnt(5)
    v_mfma_f32_32x32x16_bf16 v[40:55], a[88:91], v[88:91], v[40:55]
    v_rcp_f32 v116, v116
    v_rcp_f32 v117, v117
    v_mul_f32 v24, v24, v116
    v_mfma_f32_32x32x16_bf16 v[56:71], a[200:203], v[88:91], v[56:71]
    buffer_load_dwordx4 a[84:87], v155, s[56:59], s22 offen offset:0 sc1
    s_waitcnt lgkmcnt(4)
    v_mfma_f32_32x32x16_bf16 v[40:55], a[92:95], v[92:95], v[40:55]
    v_rcp_f32 v118, v118
    v_mul_f32 v25, v25, v117
    v_rcp_f32 v119, v119
    v_mul_f32 v26, v26, v118
    v_mfma_f32_32x32x16_bf16 v[56:71], a[204:207], v[92:95], v[56:71]
    buffer_load_dwordx4 a[88:91], v153, s[56:59], s22 offen offset:1024 sc1
    s_waitcnt lgkmcnt(3)
    v_mfma_f32_32x32x16_bf16 v[40:55], a[96:99], v[72:75], v[40:55]
    v_rcp_f32 v120, v120
    v_mul_f32 v27, v27, v119
    v_rcp_f32 v121, v121
    v_mul_f32 v28, v28, v120
    v_mfma_f32_32x32x16_bf16 v[56:71], a[208:211], v[72:75], v[56:71]
    buffer_load_dwordx4 a[92:95], v155, s[56:59], s22 offen offset:1024 sc1
    s_waitcnt lgkmcnt(2)
    v_mfma_f32_32x32x16_bf16 v[40:55], a[100:103], v[76:79], v[40:55]
    v_rcp_f32 v122, v122
    v_mul_f32 v29, v29, v121
    v_rcp_f32 v123, v123
    v_mul_f32 v30, v30, v122
    v_mfma_f32_32x32x16_bf16 v[56:71], a[212:215], v[76:79], v[56:71]
    buffer_load_dwordx4 a[96:99], v153, s[56:59], s22 offen offset:2048 sc1
    s_waitcnt lgkmcnt(1)
    v_mfma_f32_32x32x16_bf16 v[40:55], a[104:107], v[80:83], v[40:55]
    v_cvt_pk_bf16_f32 v32, v24, v25
    v_cvt_pk_bf16_f32 v33, v26, v27
    v_cvt_pk_bf16_f32 v34, v28, v29
    v_mul_f32 v31, v31, v123
    v_mfma_f32_32x32x16_bf16 v[56:71], a[216:219], v[80:83], v[56:71]
    buffer_load_dwordx4 a[100:103], v155, s[56:59], s22 offen offset:2048 sc1
    s_waitcnt lgkmcnt(0)
    v_mfma_f32_32x32x16_bf16 v[40:55], a[108:111], v[84:87], v[40:55]
    v_cvt_pk_bf16_f32 v35, v30, v31
    buffer_store_dwordx4 v[32:35], v240, s[56:59], s13 offen offset:1024 sc1
    s_lshr_b32 s79, s72, 1
    v_mfma_f32_32x32x16_bf16 v[56:71], a[220:223], v[84:87], v[56:71]
    s_lshl_b32 s6, s79, 2
    s_and_b32 s80, s72, 1
    s_add_u32 s6, s6, s80
    s_waitcnt lgkmcnt(15)
    v_mfma_f32_32x32x16_bf16 v[40:55], v[132:135], v[102:105], v[40:55]
    v_mfma_f32_32x32x16_bf16 v[56:71], v[136:139], v[102:105], v[56:71]
    s_lshl_b32 s79, s79, 8
    s_add_u32 s79, s79, 2236416
    v_mov_b32 v249, s79
    buffer_load_dword v248, v249, s[56:59], 0 offen sc1
    s_mul_i32 s77, s6, 112
    s_mul_i32 s78, s68, 28
    s_add_u32 s77, s77, s78
    s_lshl_b32 s77, s77, 10
    s_add_u32 s77, s77, 11534336
    s_add_u32 s81, s76, 0
    s_and_b32 s81, s81, 3
    s_mul_i32 s81, s81, 7168
    s_add_u32 s15, s81, s77
    s_add_u32 s81, s76, 1
    s_and_b32 s81, s81, 3
    s_mul_i32 s81, s81, 7168
    s_add_u32 s16, s81, s77
    s_add_u32 s81, s76, 2
    s_and_b32 s81, s81, 3
    s_mul_i32 s81, s81, 7168
    s_add_u32 s17, s81, s77
    s_add_u32 s81, s76, 3
    s_and_b32 s81, s81, 3
    s_mul_i32 s81, s81, 7168
    s_add_u32 s18, s81, s77
    v_add_u32 v242, 229376, v240
    v_add_u32 v243, 4096, v242
    s_lshr_b32 s78, s68, 1
    s_mul_i32 s77, s6, 28
    s_lshl_b32 s79, s5, 1
    s_add_u32 s79, s79, s78
    s_add_u32 s77, s77, s79
    s_lshl_b32 s77, s77, 10
    s_add_u32 s7, s77, 3145728
    s_mul_i32 s77, s6, 28672
    s_lshl_b32 s79, s79, 5
    s_add_u32 s8, s77, s79
    s_xor_b32 s80, s68, 1
    s_mul_i32 s80, s80, 6144
    s_add_u32 s80, s80, 0
    v_add_u32 v244, s80, v240
    s_xor_b32 s80, s68, 2
    s_mul_i32 s80, s80, 6144
    s_add_u32 s80, s80, 2048
    v_add_u32 v245, s80, v240
    s_xor_b32 s80, s68, 3
    s_mul_i32 s80, s80, 6144
    s_add_u32 s80, s80, 4096
    v_add_u32 v246, s80, v240
    s_mul_i32 s80, s68, 6144
    v_add_u32 v247, s80, v240
    v_mul_f32 v116, v114, v40
    v_mul_f32 v117, v114, v41
    v_mul_f32 v118, v114, v42
    v_mul_f32 v119, v114, v43
    v_mul_f32 v120, v114, v44
    v_mul_f32 v121, v114, v45
    v_mul_f32 v122, v114, v46
    v_mul_f32 v123, v114, v47
    v_exp_f32 v116, v116
    v_mul_f32 v40, v40, v48
    v_exp_f32 v117, v117
    v_mul_f32 v41, v41, v49
    v_exp_f32 v118, v118
    v_mul_f32 v42, v42, v50
    v_exp_f32 v119, v119
    v_mul_f32 v43, v43, v51
    v_exp_f32 v120, v120
    v_mul_f32 v44, v44, v52
    v_exp_f32 v121, v121
    v_mul_f32 v45, v45, v53
    v_exp_f32 v122, v122
    v_mul_f32 v46, v46, v54
    v_exp_f32 v123, v123
    v_mul_f32 v47, v47, v55
    v_fma_f32 v116, v116, v115, v115
    v_fma_f32 v117, v117, v115, v115
    v_fma_f32 v118, v118, v115, v115
    v_fma_f32 v119, v119, v115, v115
    v_fma_f32 v120, v120, v115, v115
    v_fma_f32 v121, v121, v115, v115
    v_fma_f32 v122, v122, v115, v115
    v_fma_f32 v123, v123, v115, v115
    v_rcp_f32 v116, v116
    v_rcp_f32 v117, v117
    v_mul_f32 v40, v40, v116
    v_rcp_f32 v118, v118
    v_mul_f32 v41, v41, v117
    v_rcp_f32 v119, v119
    v_mul_f32 v42, v42, v118
    v_rcp_f32 v120, v120
    v_mul_f32 v43, v43, v119
    v_rcp_f32 v121, v121
    v_mul_f32 v44, v44, v120
    v_rcp_f32 v122, v122
    v_mul_f32 v45, v45, v121
    v_rcp_f32 v123, v123
    v_mul_f32 v46, v46, v122
    v_cvt_pk_bf16_f32 v48, v40, v41
    v_cvt_pk_bf16_f32 v49, v42, v43
    v_cvt_pk_bf16_f32 v50, v44, v45
    v_mul_f32 v47, v47, v123
    v_cvt_pk_bf16_f32 v51, v46, v47
    buffer_store_dwordx4 v[48:51], v240, s[56:59], s14 offen offset:0 sc1
    v_mul_f32 v116, v114, v56
    v_mul_f32 v117, v114, v57
    v_mul_f32 v118, v114, v58
    v_mul_f32 v119, v114, v59
    v_mul_f32 v120, v114, v60
    v_mul_f32 v121, v114, v61
    v_mul_f32 v122, v114, v62
    v_mul_f32 v123, v114, v63
    v_exp_f32 v116, v116
    v_mul_f32 v56, v56, v64
    v_exp_f32 v117, v117
    v_mul_f32 v57, v57, v65
    v_exp_f32 v118, v118
    v_mul_f32 v58, v58, v66
    v_exp_f32 v119, v119
    v_mul_f32 v59, v59, v67
    v_exp_f32 v120, v120
    v_mul_f32 v60, v60, v68
    v_exp_f32 v121, v121
    v_mul_f32 v61, v61, v69
    v_exp_f32 v122, v122
    v_mul_f32 v62, v62, v70
    v_exp_f32 v123, v123
    v_mul_f32 v63, v63, v71
    v_fma_f32 v116, v116, v115, v115
    v_fma_f32 v117, v117, v115, v115
    v_fma_f32 v118, v118, v115, v115
    v_fma_f32 v119, v119, v115, v115
    v_fma_f32 v120, v120, v115, v115
    v_fma_f32 v121, v121, v115, v115
    v_fma_f32 v122, v122, v115, v115
    v_fma_f32 v123, v123, v115, v115
    v_rcp_f32 v116, v116
    v_rcp_f32 v117, v117
    v_mul_f32 v56, v56, v116
    v_rcp_f32 v118, v118
    v_mul_f32 v57, v57, v117
    v_rcp_f32 v119, v119
    v_mul_f32 v58, v58, v118
    v_rcp_f32 v120, v120
    v_mul_f32 v59, v59, v119
    v_rcp_f32 v121, v121
    v_mul_f32 v60, v60, v120
    v_rcp_f32 v122, v122
    v_mul_f32 v61, v61, v121
    v_rcp_f32 v123, v123
    v_mul_f32 v62, v62, v122
    v_cvt_pk_bf16_f32 v64, v56, v57
    v_cvt_pk_bf16_f32 v65, v58, v59
    v_cvt_pk_bf16_f32 v66, v60, v61
    v_mul_f32 v63, v63, v123
    v_cvt_pk_bf16_f32 v67, v62, v63
    buffer_store_dwordx4 v[64:67], v240, s[56:59], s14 offen offset:1024 sc1
    s_mov_b32 s94, 0
    s_waitcnt vmcnt(2)
    s_branch kf_p3_chk
kf_p3:
    buffer_load_dword v248, v249, s[56:59], 0 offen sc1
    s_add_u32 s94, s94, 1
    s_waitcnt vmcnt(0)
kf_p3_chk:
    v_cmp_le_u32 vcc, 14, v248
    s_cmp_ge_u32 s94, 524288
    s_nop 3
    s_cbranch_scc1 kf_p3_ok
    s_and_b32 s84, vcc_lo, 1
    s_cmp_eq_u32 s84, 1
    s_cbranch_scc1 kf_p3_ok
    s_sleep 1
    s_branch kf_p3
kf_p3_ok:
    s_add_u32 s77, s7, 57344
    buffer_load_dwordx4 v[232:235], v240, s[56:59], s7 offen sc1
    buffer_load_dwordx4 v[236:239], v240, s[56:59], s77 offen sc1
    buffer_load_dwordx4 a[104:107], v240, s[56:59], s15 offen offset:0 sc1
    buffer_load_dwordx4 a[108:111], v240, s[56:59], s15 offen offset:1024 sc1
    buffer_load_dwordx4 a[112:115], v240, s[56:59], s15 offen offset:2048 sc1
    buffer_load_dwordx4 a[116:119], v240, s[56:59], s15 offen offset:3072 sc1
    buffer_load_dwordx4 a[120:123], v241, s[56:59], s15 offen offset:0 sc1
    buffer_load_dwordx4 a[124:127], v241, s[56:59], s15 offen offset:1024 sc1
    buffer_load_dwordx4 a[128:131], v241, s[56:59], s15 offen offset:2048 sc1
    buffer_load_dwordx4 a[132:135], v240, s[56:59], s16 offen offset:0 sc1
    s_lshl_b32 s83, s74, 8
    s_add_u32 s83, s83, 2236544
    s_waitcnt vmcnt(10)
    s_barrier
    v_mov_b32 v2, 1
    v_mov_b32 v3, 0
    s_mov_b64 exec, 1
    buffer_atomic_add v2, v3, s[60:63], s83 offen sc1
    s_mov_b64 exec, -1
    buffer_load_dwordx4 a[136:139], v240, s[56:59], s16 offen offset:1024 sc1
    buffer_load_dwordx4 a[140:143], v240, s[56:59], s16 offen offset:2048 sc1
    buffer_load_dwordx4 a[144:147], v240, s[56:59], s16 offen offset:3072 sc1
    buffer_load_dwordx4 a[148:151], v241, s[56:59], s16 offen offset:0 sc1
    buffer_load_dwordx4 a[152:155], v241, s[56:59], s16 offen offset:1024 sc1
    buffer_load_dwordx4 a[156:159], v241, s[56:59], s16 offen offset:2048 sc1
    buffer_load_dwordx4 a[160:163], v240, s[56:59], s17 offen offset:0 sc1
    buffer_load_dwordx4 a[164:167], v240, s[56:59], s17 offen offset:1024 sc1
    v_add_u32 v249, 128, v249
    s_waitcnt vmcnt(16)
    v_mfma_f32_32x32x16_bf16 v[8:23], v[140:143], a[104:107], 0
    buffer_load_dwordx4 a[168:171], v240, s[56:59], s17 offen offset:2048 sc1
    v_mfma_f32_32x32x16_bf16 v[24:39], v[144:147], a[104:107], 0
    s_waitcnt vmcnt(16)
    v_mfma_f32_32x32x16_bf16 v[8:23], v[148:151], a[108:111], v[8:23]
    buffer_load_dwordx4 a[172:175], v240, s[56:59], s17 offen offset:3072 sc1
    v_mfma_f32_32x32x16_bf16 v[24:39], a[224:227], a[108:111], v[24:39]
    s_waitcnt vmcnt(16)
    v_mfma_f32_32x32x16_bf16 v[8:23], a[228:231], a[112:115], v[8:23]
    buffer_load_dwordx4 a[176:179], v241, s[56:59], s17 offen offset:0 sc1
    v_mfma_f32_32x32x16_bf16 v[24:39], a[232:235], a[112:115], v[24:39]
    s_waitcnt vmcnt(16)
    v_mfma_f32_32x32x16_bf16 v[8:23], a[236:239], a[116:119], v[8:23]
    buffer_load_dwordx4 a[180:183], v241, s[56:59], s17 offen offset:1024 sc1
    v_mfma_f32_32x32x16_bf16 v[24:39], a[240:243], a[116:119], v[24:39]
    s_waitcnt vmcnt(16)
    v_mfma_f32_32x32x16_bf16 v[8:23], a[244:247], a[120:123], v[8:23]
    buffer_load_dwordx4 a[184:187], v241, s[56:59], s17 offen offset:2048 sc1
    v_mfma_f32_32x32x16_bf16 v[24:39], a[248:251], a[120:123], v[24:39]
    s_waitcnt vmcnt(16)
    v_mfma_f32_32x32x16_bf16 v[8:23], a[252:255], a[124:127], v[8:23]
    buffer_load_dwordx4 a[188:191], v240, s[56:59], s18 offen offset:0 sc1
    v_mfma_f32_32x32x16_bf16 v[24:39], v[156:159], a[124:127], v[24:39]
    s_waitcnt vmcnt(16)
    v_mfma_f32_32x32x16_bf16 v[8:23], v[160:163], a[128:131], v[8:23]
    buffer_load_dwordx4 a[192:195], v240, s[56:59], s18 offen offset:1024 sc1
    v_mfma_f32_32x32x16_bf16 v[24:39], v[164:167], a[128:131], v[24:39]
    s_waitcnt vmcnt(16)
    v_mfma_f32_32x32x16_bf16 v[8:23], v[168:171], a[132:135], v[8:23]
    buffer_load_dwordx4 a[196:199], v240, s[56:59], s18 offen offset:2048 sc1
    v_mfma_f32_32x32x16_bf16 v[24:39], v[172:175], a[132:135], v[24:39]
    s_waitcnt vmcnt(15)
    v_mfma_f32_32x32x16_bf16 v[8:23], v[176:179], a[136:139], v[8:23]
    buffer_load_dwordx4 a[200:203], v240, s[56:59], s18 offen offset:3072 sc1
    v_mfma_f32_32x32x16_bf16 v[24:39], v[180:183], a[136:139], v[24:39]
    s_waitcnt vmcnt(15)
    v_mfma_f32_32x32x16_bf16 v[8:23], v[184:187], a[140:143], v[8:23]
    buffer_load_dwordx4 a[204:207], v241, s[56:59], s18 offen offset:0 sc1
    v_mfma_f32_32x32x16_bf16 v[24:39], v[188:191], a[140:143], v[24:39]
    s_waitcnt vmcnt(15)
    v_mfma_f32_32x32x16_bf16 v[8:23], v[192:195], a[144:147], v[8:23]
    buffer_load_dwordx4 a[208:211], v241, s[56:59], s18 offen offset:1024 sc1
    v_mfma_f32_32x32x16_bf16 v[24:39], v[196:199], a[144:147], v[24:39]
    s_waitcnt vmcnt(15)
    v_mfma_f32_32x32x16_bf16 v[8:23], v[200:203], a[148:151], v[8:23]
    buffer_load_dwordx4 a[212:215], v241, s[56:59], s18 offen offset:2048 sc1
    v_mfma_f32_32x32x16_bf16 v[24:39], v[204:207], a[148:151], v[24:39]
    s_waitcnt vmcnt(15)
    v_mfma_f32_32x32x16_bf16 v[8:23], v[208:211], a[152:155], v[8:23]
    v_mfma_f32_32x32x16_bf16 v[24:39], v[212:215], a[152:155], v[24:39]
    s_waitcnt vmcnt(14)
    v_mfma_f32_32x32x16_bf16 v[8:23], v[216:219], a[156:159], v[8:23]
    v_mfma_f32_32x32x16_bf16 v[24:39], v[220:223], a[156:159], v[24:39]
    buffer_load_dword v248, v249, s[56:59], 0 offen sc1
    s_waitcnt vmcnt(14)
    v_mfma_f32_32x32x16_bf16 v[8:23], v[224:227], a[160:163], v[8:23]
    v_mfma_f32_32x32x16_bf16 v[24:39], v[228:231], a[160:163], v[24:39]
    s_waitcnt vmcnt(13)
    v_mfma_f32_32x32x16_bf16 v[8:23], a[0:3], a[164:167], v[8:23]
    v_mfma_f32_32x32x16_bf16 v[24:39], a[4:7], a[164:167], v[24:39]
    s_waitcnt vmcnt(12)
    v_mfma_f32_32x32x16_bf16 v[8:23], a[8:11], a[168:171], v[8:23]
    v_mfma_f32_32x32x16_bf16 v[24:39], a[12:15], a[168:171], v[24:39]
    s_waitcnt vmcnt(11)
    v_mfma_f32_32x32x16_bf16 v[8:23], a[16:19], a[172:175], v[8:23]
    v_mfma_f32_32x32x16_bf16 v[24:39], a[20:23], a[172:175], v[24:39]
    s_waitcnt vmcnt(10)
    v_mfma_f32_32x32x16_bf16 v[8:23], a[24:27], a[176:179], v[8:23]
    v_mfma_f32_32x32x16_bf16 v[24:39], a[28:31], a[176:179], v[24:39]
    s_waitcnt vmcnt(9)
    v_mfma_f32_32x32x16_bf16 v[8:23], a[32:35], a[180:183], v[8:23]
    v_mfma_f32_32x32x16_bf16 v[24:39], a[36:39], a[180:183], v[24:39]
    s_waitcnt vmcnt(8)
    v_mfma_f32_32x32x16_bf16 v[8:23], a[40:43], a[184:187], v[8:23]
    v_mfma_f32_32x32x16_bf16 v[24:39], a[44:47], a[184:187], v[24:39]
    s_waitcnt vmcnt(7)
    v_mfma_f32_32x32x16_bf16 v[8:23], a[48:51], a[188:191], v[8:23]
    v_mfma_f32_32x32x16_bf16 v[24:39], a[52:55], a[188:191], v[24:39]
    s_mov_b32 s94, 0
    s_waitcnt vmcnt(0)
    s_nop 9
    s_branch kf_p4_chk
kf_p4:
    buffer_load_dword v248, v249, s[56:59], 0 offen sc1
    s_add_u32 s94, s94, 1
    s_waitcnt vmcnt(0)
kf_p4_chk:
    v_cmp_le_u32 vcc, 14, v248
    s_cmp_ge_u32 s94, 524288
    s_nop 3
    s_cbranch_scc1 kf_p4_ok
    s_and_b32 s84, vcc_lo, 1
    s_cmp_eq_u32 s84, 1
    s_cbranch_scc1 kf_p4_ok
    s_sleep 1
    s_branch kf_p4
kf_p4_ok:
    buffer_load_dwordx4 a[216:219], v242, s[56:59], s15 offen offset:0 sc1
    buffer_load_dwordx4 a[220:223], v242, s[56:59], s15 offen offset:1024 sc1
    buffer_load_dwordx4 a[104:107], v242, s[56:59], s15 offen offset:2048 sc1
    buffer_load_dwordx4 a[108:111], v242, s[56:59], s15 offen offset:3072 sc1
    buffer_load_dwordx4 a[112:115], v243, s[56:59], s15 offen offset:0 sc1
    buffer_load_dwordx4 a[116:119], v243, s[56:59], s15 offen offset:1024 sc1
    buffer_load_dwordx4 a[120:123], v243, s[56:59], s15 offen offset:2048 sc1
    buffer_load_dwordx4 a[124:127], v242, s[56:59], s16 offen offset:0 sc1
    buffer_load_dwordx4 a[128:131], v242, s[56:59], s16 offen offset:1024 sc1
    buffer_load_dwordx4 a[132:135], v242, s[56:59], s16 offen offset:2048 sc1
    s_waitcnt vmcnt(16)
    v_mfma_f32_32x32x16_bf16 v[8:23], a[56:59], a[192:195], v[8:23]
    buffer_load_dwordx4 a[136:139], v242, s[56:59], s16 offen offset:3072 sc1
    v_mfma_f32_32x32x16_bf16 v[24:39], a[60:63], a[192:195], v[24:39]
    s_waitcnt vmcnt(16)
    v_mfma_f32_32x32x16_bf16 v[8:23], a[64:67], a[196:199], v[8:23]
    buffer_load_dwordx4 a[140:143], v243, s[56:59], s16 offen offset:0 sc1
    v_mfma_f32_32x32x16_bf16 v[24:39], a[68:71], a[196:199], v[24:39]
    s_waitcnt vmcnt(16)
    v_mfma_f32_32x32x16_bf16 v[8:23], a[72:75], a[200:203], v[8:23]
    buffer_load_dwordx4 a[144:147], v243, s[56:59], s16 offen offset:1024 sc1
    v_mfma_f32_32x32x16_bf16 v[24:39], a[76:79], a[200:203], v[24:39]
    s_waitcnt vmcnt(16)
    v_mfma_f32_32x32x16_bf16 v[8:23], a[80:83], a[204:207], v[8:23]
    buffer_load_dwordx4 a[148:151], v243, s[56:59], s16 offen offset:2048 sc1
    v_mfma_f32_32x32x16_bf16 v[24:39], a[84:87], a[204:207], v[24:39]
    s_waitcnt vmcnt(16)
    v_mfma_f32_32x32x16_bf16 v[8:23], a[88:91], a[208:211], v[8:23]
    buffer_load_dwordx4 a[152:155], v242, s[56:59], s17 offen offset:0 sc1
    v_mfma_f32_32x32x16_bf16 v[24:39], a[92:95], a[208:211], v[24:39]
    s_waitcnt vmcnt(16)
    v_mfma_f32_32x32x16_bf16 v[8:23], a[96:99], a[212:215], v[8:23]
    buffer_load_dwordx4 a[156:159], v242, s[56:59], s17 offen offset:1024 sc1
    v_mfma_f32_32x32x16_bf16 v[24:39], a[100:103], a[212:215], v[24:39]
    s_waitcnt vmcnt(15)
    v_mfma_f32_32x32x16_bf16 v[40:55], v[140:143], a[216:219], 0
    buffer_load_dwordx4 a[160:163], v242, s[56:59], s17 offen offset:2048 sc1
    v_mfma_f32_32x32x16_bf16 v[56:71], v[144:147], a[216:219], 0
    s_waitcnt vmcnt(15)
    v_mfma_f32_32x32x16_bf16 v[40:55], v[148:151], a[220:223], v[40:55]
    buffer_load_dwordx4 a[164:167], v242, s[56:59], s17 offen offset:3072 sc1
    v_mfma_f32_32x32x16_bf16 v[56:71], a[224:227], a[220:223], v[56:71]
    s_nop 3
    ds_write_b128 v244, v[24:27] offset:0
    ds_write_b128 v244, v[28:31] offset:1024
    ds_write_b128 v245, v[16:19] offset:0
    ds_write_b128 v245, v[20:23] offset:1024
    ds_write_b128 v246, v[32:35] offset:0
    ds_write_b128 v246, v[36:39] offset:1024
    s_waitcnt vmcnt(15)
    v_mfma_f32_32x32x16_bf16 v[40:55], a[228:231], a[104:107], v[40:55]
    buffer_load_dwordx4 a[168:171], v243, s[56:59], s17 offen offset:0 sc1
    v_mfma_f32_32x32x16_bf16 v[56:71], a[232:235], a[104:107], v[56:71]
    s_waitcnt vmcnt(15)
    v_mfma_f32_32x32x16_bf16 v[40:55], a[236:239], a[108:111], v[40:55]
    buffer_load_dwordx4 a[172:175], v243, s[56:59], s17 offen offset:1024 sc1
    v_mfma_f32_32x32x16_bf16 v[56:71], a[240:243], a[108:111], v[56:71]
    s_waitcnt vmcnt(15)
    v_mfma_f32_32x32x16_bf16 v[40:55], a[244:247], a[112:115], v[40:55]
    buffer_load_dwordx4 a[176:179], v243, s[56:59], s17 offen offset:2048 sc1
    v_mfma_f32_32x32x16_bf16 v[56:71], a[248:251], a[112:115], v[56:71]
    s_waitcnt vmcnt(15)
    v_mfma_f32_32x32x16_bf16 v[40:55], a[252:255], a[116:119], v[40:55]
    buffer_load_dwordx4 a[180:183], v242, s[56:59], s18 offen offset:0 sc1
    v_mfma_f32_32x32x16_bf16 v[56:71], v[156:159], a[116:119], v[56:71]
    s_waitcnt vmcnt(15)
    v_mfma_f32_32x32x16_bf16 v[40:55], v[160:163], a[120:123], v[40:55]
    buffer_load_dwordx4 a[184:187], v242, s[56:59], s18 offen offset:1024 sc1
    v_mfma_f32_32x32x16_bf16 v[56:71], v[164:167], a[120:123], v[56:71]
    s_waitcnt vmcnt(15)
    v_mfma_f32_32x32x16_bf16 v[40:55], v[168:171], a[124:127], v[40:55]
    buffer_load_dwordx4 a[188:191], v242, s[56:59], s18 offen offset:2048 sc1
    v_mfma_f32_32x32x16_bf16 v[56:71], v[172:175], a[124:127], v[56:71]
    s_waitcnt lgkmcnt(0)
    s_barrier
    s_waitcnt vmcnt(15)
    v_mfma_f32_32x32x16_bf16 v[40:55], v[176:179], a[128:131], v[40:55]
    buffer_load_dwordx4 a[192:195], v242, s[56:59], s18 offen offset:3072 sc1
    v_mfma_f32_32x32x16_bf16 v[56:71], v[180:183], a[128:131], v[56:71]
    ds_read_b128 v[72:75], v247 offset:0
    ds_read_b128 v[76:79], v247 offset:1024
    ds_read_b128 v[80:83], v247 offset:2048
    ds_read_b128 v[84:87], v247 offset:3072
    s_waitcnt vmcnt(15)
    v_mfma_f32_32x32x16_bf16 v[40:55], v[184:187], a[132:135], v[40:55]
    buffer_load_dwordx4 a[196:199], v243, s[56:59], s18 offen offset:0 sc1
    v_mfma_f32_32x32x16_bf16 v[56:71], v[188:191], a[132:135], v[56:71]
    ds_read_b128 v[88:91], v247 offset:4096
    ds_read_b128 v[92:95], v247 offset:5120
    v_permlane32_swap_b32 v232, v234
    v_permlane32_swap_b32 v233, v235
    v_lshlrev_b32 v104, 16, v232
    s_waitcnt vmcnt(15)
    v_mfma_f32_32x32x16_bf16 v[40:55], v[192:195], a[136:139], v[40:55]
    buffer_load_dwordx4 a[200:203], v243, s[56:59], s18 offen offset:1024 sc1
    v_mfma_f32_32x32x16_bf16 v[56:71], v[196:199], a[136:139], v[56:71]
    v_and_b32 v105, 0xffff0000, v232
    v_lshlrev_b32 v106, 16, v233
    v_and_b32 v107, 0xffff0000, v233
    v_lshlrev_b32 v108, 16, v234
    v_and_b32 v109, 0xffff0000, v234
    s_waitcnt vmcnt(15)
    v_mfma_f32_32x32x16_bf16 v[40:55], v[200:203], a[140:143], v[40:55]
    buffer_load_dwordx4 a[204:207], v243, s[56:59], s18 offen offset:2048 sc1
    v_mfma_f32_32x32x16_bf16 v[56:71], v[204:207], a[140:143], v[56:71]
    v_lshlrev_b32 v110, 16, v235
    v_and_b32 v111, 0xffff0000, v235
    v_add_f32 v8, v8, v104
    v_add_f32 v9, v9, v105
    v_add_f32 v10, v10, v106
    s_waitcnt vmcnt(15)
    v_mfma_f32_32x32x16_bf16 v[40:55], v[208:211], a[144:147], v[40:55]
    v_mfma_f32_32x32x16_bf16 v[56:71], v[212:215], a[144:147], v[56:71]
    v_add_f32 v11, v11, v107
    v_add_f32 v12, v12, v108
    v_add_f32 v13, v13, v109
    v_add_f32 v14, v14, v110
    v_add_f32 v15, v15, v111
    s_waitcnt lgkmcnt(0)
    s_waitcnt vmcnt(14)
    v_mfma_f32_32x32x16_bf16 v[40:55], v[216:219], a[148:151], v[40:55]
    v_mfma_f32_32x32x16_bf16 v[56:71], v[220:223], a[148:151], v[56:71]
    v_add_f32 v8, v8, v72
    v_add_f32 v80, v80, v88
    v_add_f32 v9, v9, v73
    v_add_f32 v81, v81, v89
    v_add_f32 v10, v10, v74
    v_add_f32 v82, v82, v90
    s_waitcnt vmcnt(13)
    v_mfma_f32_32x32x16_bf16 v[40:55], v[224:227], a[152:155], v[40:55]
    v_mfma_f32_32x32x16_bf16 v[56:71], v[228:231], a[152:155], v[56:71]
    v_add_f32 v11, v11, v75
    v_add_f32 v83, v83, v91
    v_add_f32 v12, v12, v76
    v_add_f32 v84, v84, v92
    v_add_f32 v13, v13, v77
    v_add_f32 v85, v85, v93
    s_waitcnt vmcnt(12)
    v_mfma_f32_32x32x16_bf16 v[40:55], a[0:3], a[156:159], v[40:55]
    v_mfma_f32_32x32x16_bf16 v[56:71], a[4:7], a[156:159], v[56:71]
    v_add_f32 v14, v14, v78
    v_add_f32 v86, v86, v94
    v_add_f32 v15, v15, v79
    v_add_f32 v87, v87, v95
    v_add_f32 v8, v8, v80
    s_waitcnt vmcnt(11)
    v_mfma_f32_32x32x16_bf16 v[40:55], a[8:11], a[160:163], v[40:55]
    v_mfma_f32_32x32x16_bf16 v[56:71], a[12:15], a[160:163], v[56:71]
    v_add_f32 v9, v9, v81
    v_add_f32 v10, v10, v82
    v_add_f32 v11, v11, v83
    v_add_f32 v12, v12, v84
    v_add_f32 v13, v13, v85
    v_add_f32 v14, v14, v86
    s_waitcnt vmcnt(10)
    v_mfma_f32_32x32x16_bf16 v[40:55], a[16:19], a[164:167], v[40:55]
    v_mfma_f32_32x32x16_bf16 v[56:71], a[20:23], a[164:167], v[56:71]
    v_add_f32 v15, v15, v87
    v_cvt_pk_bf16_f32 v232, v8, v9
    v_cvt_pk_bf16_f32 v233, v10, v11
    v_cvt_pk_bf16_f32 v234, v12, v13
    v_cvt_pk_bf16_f32 v235, v14, v15
    s_waitcnt vmcnt(9)
    v_mfma_f32_32x32x16_bf16 v[40:55], a[24:27], a[168:171], v[40:55]
    v_mfma_f32_32x32x16_bf16 v[56:71], a[28:31], a[168:171], v[56:71]
    s_add_u32 s78, s8, 0
    s_nop 0
    v_permlane32_swap_b32 v232, v234
    v_permlane32_swap_b32 v233, v235
    s_waitcnt vmcnt(8)
    v_mfma_f32_32x32x16_bf16 v[40:55], a[32:35], a[172:175], v[40:55]
    v_mfma_f32_32x32x16_bf16 v[56:71], a[36:39], a[172:175], v[56:71]
    buffer_store_dwordx4 v[232:235], v251, s[48:51], s78 offen
    s_waitcnt vmcnt(8)
    v_mfma_f32_32x32x16_bf16 v[40:55], a[40:43], a[176:179], v[40:55]
    v_mfma_f32_32x32x16_bf16 v[56:71], a[44:47], a[176:179], v[56:71]
    s_waitcnt vmcnt(7)
    v_mfma_f32_32x32x16_bf16 v[40:55], a[48:51], a[180:183], v[40:55]
    v_mfma_f32_32x32x16_bf16 v[56:71], a[52:55], a[180:183], v[56:71]
    s_waitcnt vmcnt(6)
    v_mfma_f32_32x32x16_bf16 v[40:55], a[56:59], a[184:187], v[40:55]
    v_mfma_f32_32x32x16_bf16 v[56:71], a[60:63], a[184:187], v[56:71]
    s_waitcnt vmcnt(5)
    v_mfma_f32_32x32x16_bf16 v[40:55], a[64:67], a[188:191], v[40:55]
    v_mfma_f32_32x32x16_bf16 v[56:71], a[68:71], a[188:191], v[56:71]
    s_waitcnt vmcnt(4)
    v_mfma_f32_32x32x16_bf16 v[40:55], a[72:75], a[192:195], v[40:55]
    v_mfma_f32_32x32x16_bf16 v[56:71], a[76:79], a[192:195], v[56:71]
    s_waitcnt vmcnt(3)
    v_mfma_f32_32x32x16_bf16 v[40:55], a[80:83], a[196:199], v[40:55]
    v_mfma_f32_32x32x16_bf16 v[56:71], a[84:87], a[196:199], v[56:71]
    s_waitcnt vmcnt(2)
    v_mfma_f32_32x32x16_bf16 v[40:55], a[88:91], a[200:203], v[40:55]
    v_mfma_f32_32x32x16_bf16 v[56:71], a[92:95], a[200:203], v[56:71]
    s_waitcnt vmcnt(1)
    v_mfma_f32_32x32x16_bf16 v[40:55], a[96:99], a[204:207], v[40:55]
    v_mfma_f32_32x32x16_bf16 v[56:71], a[100:103], a[204:207], v[56:71]
    s_nop 11
    ds_write_b128 v244, v[56:59] offset:24576
    ds_write_b128 v244, v[60:63] offset:25600
    ds_write_b128 v245, v[48:51] offset:24576
    ds_write_b128 v245, v[52:55] offset:25600
    ds_write_b128 v246, v[64:67] offset:24576
    ds_write_b128 v246, v[68:71] offset:25600
    s_waitcnt lgkmcnt(0)
    s_barrier
    ds_read_b128 v[72:75], v247 offset:24576
    ds_read_b128 v[76:79], v247 offset:25600
    ds_read_b128 v[80:83], v247 offset:26624
    ds_read_b128 v[84:87], v247 offset:27648
    ds_read_b128 v[88:91], v247 offset:28672
    ds_read_b128 v[92:95], v247 offset:29696
    v_permlane32_swap_b32 v236, v238
    v_permlane32_swap_b32 v237, v239
    v_lshlrev_b32 v104, 16, v236
    v_and_b32 v105, 0xffff0000, v236
    v_lshlrev_b32 v106, 16, v237
    v_and_b32 v107, 0xffff0000, v237
    v_lshlrev_b32 v108, 16, v238
    v_and_b32 v109, 0xffff0000, v238
    v_lshlrev_b32 v110, 16, v239
    v_and_b32 v111, 0xffff0000, v239
    v_pk_add_f32 v[40:41], v[40:41], v[104:105]
    v_pk_add_f32 v[42:43], v[42:43], v[106:107]
    v_pk_add_f32 v[44:45], v[44:45], v[108:109]
    v_pk_add_f32 v[46:47], v[46:47], v[110:111]
    s_waitcnt lgkmcnt(0)
    v_pk_add_f32 v[40:41], v[40:41], v[72:73]
    v_pk_add_f32 v[80:81], v[80:81], v[88:89]
    v_pk_add_f32 v[42:43], v[42:43], v[74:75]
    v_pk_add_f32 v[82:83], v[82:83], v[90:91]
    v_pk_add_f32 v[44:45], v[44:45], v[76:77]
    v_pk_add_f32 v[84:85], v[84:85], v[92:93]
    v_pk_add_f32 v[46:47], v[46:47], v[78:79]
    v_pk_add_f32 v[86:87], v[86:87], v[94:95]
    v_pk_add_f32 v[40:41], v[40:41], v[80:81]
    v_pk_add_f32 v[42:43], v[42:43], v[82:83]
    v_pk_add_f32 v[44:45], v[44:45], v[84:85]
    v_pk_add_f32 v[46:47], v[46:47], v[86:87]
    v_cvt_pk_bf16_f32 v236, v40, v41
    v_cvt_pk_bf16_f32 v237, v42, v43
    v_cvt_pk_bf16_f32 v238, v44, v45
    v_cvt_pk_bf16_f32 v239, v46, v47
    s_add_u32 s78, s8, 57344
    s_nop 0
    v_permlane32_swap_b32 v236, v238
    v_permlane32_swap_b32 v237, v239
    buffer_store_dwordx4 v[236:239], v251, s[48:51], s78 offen
    s_endpgm
    s_nop 0
kf_pack:
    s_bfe_u32 s82, s2, 0x30003
    s_and_b32 s77, s2, 1
    s_lshl_b32 s77, s77, 3
    s_add_u32 s82, s82, s77
    s_and_b32 s77, s2, 4
    s_lshl_b32 s77, s77, 2
    s_add_u32 s82, s82, s77
    s_cmp_ge_u32 s82, 28
    s_cbranch_scc1 kf_end
    s_lshl_b32 s77, s82, 2
    s_add_u32 s77, s77, s68
    s_mul_i32 s78, s77, 14336
    s_mul_i32 s79, s68, 14336
    s_add_u32 s80, s78, 0
    s_add_u32 m0, s79, 0
    s_nop 0
    buffer_load_dwordx4 v240, s[44:47], s80 offen offset:0 lds
    buffer_load_dwordx4 v240, s[44:47], s80 offen offset:1024 lds
    buffer_load_dwordx4 v240, s[44:47], s80 offen offset:2048 lds
    buffer_load_dwordx4 v240, s[44:47], s80 offen offset:3072 lds
    s_add_u32 s80, s78, 4096
    s_add_u32 m0, s79, 4096
    s_nop 0
    buffer_load_dwordx4 v240, s[44:47], s80 offen offset:0 lds
    buffer_load_dwordx4 v240, s[44:47], s80 offen offset:1024 lds
    buffer_load_dwordx4 v240, s[44:47], s80 offen offset:2048 lds
    buffer_load_dwordx4 v240, s[44:47], s80 offen offset:3072 lds
    s_add_u32 s80, s78, 8192
    s_add_u32 m0, s79, 8192
    s_nop 0
    buffer_load_dwordx4 v240, s[44:47], s80 offen offset:0 lds
    buffer_load_dwordx4 v240, s[44:47], s80 offen offset:1024 lds
    buffer_load_dwordx4 v240, s[44:47], s80 offen offset:2048 lds
    buffer_load_dwordx4 v240, s[44:47], s80 offen offset:3072 lds
    s_add_u32 s80, s78, 12288
    s_add_u32 m0, s79, 12288
    s_nop 0
    buffer_load_dwordx4 v240, s[44:47], s80 offen offset:0 lds
    buffer_load_dwordx4 v240, s[44:47], s80 offen offset:1024 lds
    v_lshrrev_b32 v3, 5, v1
    v_bfe_u32 v4, v1, 2, 2
    v_lshl_add_u32 v4, v3, 2, v4
    v_mul_u32_u24 v4, 896, v4
    v_bfe_u32 v5, v1, 4, 1
    v_lshl_add_u32 v4, v5, 5, v4
    v_and_b32 v5, 3, v1
    v_lshl_add_u32 v4, v5, 3, v4
    v_add_u32 v4, s79, v4
    s_lshl_b32 s78, s77, 10
    s_add_u32 s78, s78, 9437184
    s_mul_i32 s82, s82, 37
    s_lshr_b32 s82, s82, 8
    s_waitcnt vmcnt(0)
    ds_read_b64_tr_b16 v[80:81], v4 offset:0
    ds_read_b64_tr_b16 v[82:83], v4 offset:7168
    ds_read_b64_tr_b16 v[84:85], v4 offset:64
    ds_read_b64_tr_b16 v[86:87], v4 offset:7232
    ds_read_b64_tr_b16 v[88:89], v4 offset:128
    ds_read_b64_tr_b16 v[90:91], v4 offset:7296
    ds_read_b64_tr_b16 v[92:93], v4 offset:192
    ds_read_b64_tr_b16 v[94:95], v4 offset:7360
    ds_read_b64_tr_b16 v[96:97], v4 offset:256
    ds_read_b64_tr_b16 v[98:99], v4 offset:7424
    s_waitcnt lgkmcnt(8)
    buffer_store_dwordx4 v[80:83], v240, s[56:59], s78 offen sc1
    s_add_u32 s78, s78, 114688
    ds_read_b64_tr_b16 v[100:101], v4 offset:320
    ds_read_b64_tr_b16 v[102:103], v4 offset:7488
    s_waitcnt lgkmcnt(8)
    buffer_store_dwordx4 v[84:87], v240, s[56:59], s78 offen sc1
    s_add_u32 s78, s78, 114688
    ds_read_b64_tr_b16 v[104:105], v4 offset:384
    ds_read_b64_tr_b16 v[106:107], v4 offset:7552
    s_waitcnt lgkmcnt(8)
    buffer_store_dwordx4 v[88:91], v240, s[56:59], s78 offen sc1
    s_add_u32 s78, s78, 114688
    ds_read_b64_tr_b16 v[108:109], v4 offset:448
    ds_read_b64_tr_b16 v[110:111], v4 offset:7616
    s_waitcnt lgkmcnt(8)
    buffer_store_dwordx4 v[92:95], v240, s[56:59], s78 offen sc1
    s_add_u32 s78, s78, 114688
    ds_read_b64_tr_b16 v[112:113], v4 offset:512
    ds_read_b64_tr_b16 v[114:115], v4 offset:7680
    s_waitcnt lgkmcnt(8)
    buffer_store_dwordx4 v[96:99], v240, s[56:59], s78 offen sc1
    s_add_u32 s78, s78, 114688
    ds_read_b64_tr_b16 v[116:117], v4 offset:576
    ds_read_b64_tr_b16 v[118:119], v4 offset:7744
    s_waitcnt lgkmcnt(8)
    buffer_store_dwordx4 v[100:103], v240, s[56:59], s78 offen sc1
    s_add_u32 s78, s78, 114688
    ds_read_b64_tr_b16 v[120:121], v4 offset:640
    ds_read_b64_tr_b16 v[122:123], v4 offset:7808
    s_waitcnt lgkmcnt(8)
    buffer_store_dwordx4 v[104:107], v240, s[56:59], s78 offen sc1
    s_add_u32 s78, s78, 114688
    ds_read_b64_tr_b16 v[124:125], v4 offset:704
    ds_read_b64_tr_b16 v[126:127], v4 offset:7872
    s_waitcnt lgkmcnt(8)
    buffer_store_dwordx4 v[108:111], v240, s[56:59], s78 offen sc1
    s_add_u32 s78, s78, 114688
    ds_read_b64_tr_b16 v[128:129], v4 offset:768
    ds_read_b64_tr_b16 v[130:131], v4 offset:7936
    s_waitcnt lgkmcnt(8)
    buffer_store_dwordx4 v[112:115], v240, s[56:59], s78 offen sc1
    s_add_u32 s78, s78, 114688
    ds_read_b64_tr_b16 v[132:133], v4 offset:832
    ds_read_b64_tr_b16 v[134:135], v4 offset:8000
    s_waitcnt lgkmcnt(8)
    buffer_store_dwordx4 v[116:119], v240, s[56:59], s78 offen sc1
    s_add_u32 s78, s78, 114688
    s_waitcnt lgkmcnt(6)
    buffer_store_dwordx4 v[120:123], v240, s[56:59], s78 offen sc1
    s_add_u32 s78, s78, 114688
    s_waitcnt lgkmcnt(4)
    buffer_store_dwordx4 v[124:127], v240, s[56:59], s78 offen sc1
    s_add_u32 s78, s78, 114688
    s_waitcnt lgkmcnt(2)
    buffer_store_dwordx4 v[128:131], v240, s[56:59], s78 offen sc1
    s_add_u32 s78, s78, 114688
    s_waitcnt lgkmcnt(0)
    buffer_store_dwordx4 v[132:135], v240, s[56:59], s78 offen sc1
    s_add_u32 s78, s78, 114688
    s_lshl_b32 s83, s82, 8
    s_add_u32 s83, s83, 2248704
    s_waitcnt vmcnt(0)
    s_barrier
    v_mov_b32 v2, 1
    v_mov_b32 v3, 0
    s_mov_b64 exec, 1
    buffer_atomic_add v2, v3, s[60:63], s83 offen sc1
    s_mov_b64 exec, -1
kf_end:
    s_endpgm
kf_pad:
.fill (49664 - (kf_pad - sequential_preLN__linear_attn_block__swiglu_ffn__prompt_kernel)) / 4, 4, 0xbf800000
.section .rodata,"a"
.p2align 6
.amdhsa_kernel sequential_preLN__linear_attn_block__swiglu_ffn__prompt_kernel
  .amdhsa_next_free_vgpr 512
  .amdhsa_next_free_sgpr 102
  .amdhsa_accum_offset 256
  .amdhsa_group_segment_fixed_size 0
  .amdhsa_kernarg_size 80
  .amdhsa_user_sgpr_count 2
  .amdhsa_user_sgpr_kernarg_segment_ptr 1
  .amdhsa_system_sgpr_workgroup_id_x 1
.end_amdhsa_kernel
```
